```python
import torch

def _softmax(x, axis=-1):
    return torch.softmax(x, dim=axis)
def _gelu(x):
    return torch.nn.functional.gelu(x, approximate="tanh")
def _silu(x):
    return torch.nn.functional.silu(x)
def _sigmoid(x):
    return torch.sigmoid(x)
def _layernorm(x, axis=-1, eps=1e-5):
    m = x.mean(dim=axis, keepdim=True)
    v = x.var(dim=axis, keepdim=True, unbiased=False)
    return (x - m) / torch.sqrt(v + eps)
def _scatter_add(tgt, idx, src, axis=0):
    return tgt.clone().index_add_(axis, idx, src)
def _segment_sum(src, seg, n):
    out = torch.zeros((n,) + src.shape[1:], dtype=src.dtype)
    return out.index_add_(0, seg, src)
def _pad(x, pw):
    flat = tuple(v for pair in reversed(pw) for v in pair)
    return torch.nn.functional.pad(x, flat)

kernel_name = 'concat_heads__sliding_block_cached__compressed_kv_cla__decode'

def setup_inputs():

    _w = (lambda a: (lambda t: t.to(torch.bfloat16) if t.is_floating_point() else t)(torch.as_tensor(a)))
    def _A_setup():
        B, Sq, D = 2, 1, 512
        Hq, Hkv, Sk, Dh = 32, 8, 8192, 128
        assert Hq % Hkv == 0, (Hq, Hkv)
        return {
            "x": _w((lambda *s: torch.randn(*s, dtype=torch.bfloat16) * 1.6)(B, Sq, D)),
            "k_cache": _w((lambda *s: torch.randn(*s, dtype=torch.bfloat16) * 1.6)(B, Hkv, Sk, Dh)),
            "v_cache": _w((lambda *s: torch.randn(*s, dtype=torch.bfloat16) * 0.05)(B, Hkv, Sk, Dh)),
            "wq": _w((lambda *s: torch.randn(*s, dtype=torch.bfloat16) * 1.6)(D, Hq * Dh) * (D ** -0.5)),
            "wo": _w((lambda *s: torch.randn(*s, dtype=torch.bfloat16) * 0.05)(Hq * Dh, D) * ((Hq * Dh) ** -0.5)),
        }
    _A_in = _A_setup()

    def _B_setup():
        B, H, Sq, Sk, D, M = 2, 32, 1, 8192, 128, 512
        Dc = 4 * D
        return {
            "x": _w((lambda *s: torch.randn(*s, dtype=torch.bfloat16) * 3.2)(B, Sq, M)),
            "c_kv": _w((lambda *s: torch.randn(*s, dtype=torch.bfloat16) * 0.1)(B, Sk, Dc)),
            "w_q": _w((lambda *s: torch.randn(*s, dtype=torch.bfloat16) * 6.4)(M, H, D) * (M ** -0.5)),
            "w_uk": _w((lambda *s: torch.randn(*s, dtype=torch.bfloat16) * 6.4)(Dc, H, D) * (Dc ** -0.5)),
            "w_uv": _w((lambda *s: torch.randn(*s, dtype=torch.bfloat16) * 0.1)(Dc, H, D) * (Dc ** -0.5)),
            "w_o": _w((lambda *s: torch.randn(*s, dtype=torch.bfloat16) * 0.1)(H, D, M) * ((H * D) ** -0.5)),
        }
    _B_in = _B_setup()

    return {
        "A_x": _A_in["x"],
        "A_k_cache": _A_in["k_cache"],
        "A_v_cache": _A_in["v_cache"],
        "A_wq": _A_in["wq"],
        "A_wo": _A_in["wo"],
        "B_x": _B_in["x"],
        "B_c_kv": _B_in["c_kv"],
        "B_w_q": _B_in["w_q"],
        "B_w_uk": _B_in["w_uk"],
        "B_w_uv": _B_in["w_uv"],
        "B_w_o": _B_in["w_o"],
    }

def reference(A_x, A_k_cache, A_v_cache, A_wq, A_wo, B_x, B_c_kv, B_w_q, B_w_uk, B_w_uv, B_w_o):
    def _A_ref(x, k_cache, v_cache, wq, wo):
        B, Sq, D = x.shape
        Hq, Dh = 32, 128
        Hkv, Sk = k_cache.shape[1], k_cache.shape[2]
        W = min(4096, max(256, Sk // 4))
        rep = Hq // Hkv
        q = (lambda x, *d: x.permute(*d))((x @ wq).reshape(B, Sq, Hq, Dh), 0, 2, 1, 3)
        k = (lambda x, n, axis: torch.repeat_interleave(x, n, dim=axis))(k_cache[:, :, Sk - W:, :], rep, axis=1)
        v = (lambda x, n, axis: torch.repeat_interleave(x, n, dim=axis))(v_cache[:, :, Sk - W:, :], rep, axis=1)
        scores = torch.einsum("bhqd,bhkd->bhqk", q, k) * (Dh ** -0.5)
        p = _softmax(scores, axis=-1)
        o = torch.einsum("bhqk,bhkd->bhqd", p, v)
        return (lambda x, *d: x.permute(*d))(o, 0, 2, 1, 3).reshape(B, Sq, Hq * Dh) @ wo

    def _B_ref(x, c_kv, w_q, w_uk, w_uv, w_o):
        B, Sq, M = x.shape[0], x.shape[1], x.shape[2]
        Sk = c_kv.shape[1]
        H, D = w_q.shape[1], w_q.shape[2]
        q = torch.einsum("bqm,mhd->bhqd", x, w_q)
        k = torch.einsum("bkc,chd->bhkd", c_kv, w_uk)
        v = torch.einsum("bkc,chd->bhkd", c_kv, w_uv)
        scores = torch.einsum("bhqd,bhkd->bhqk", q, k) * (D ** -0.5)
        off = Sk - Sq
        qi = torch.arange(Sq)[:, None]
        kj = torch.arange(Sk)[None, :]
        cmask = kj <= (qi + off)
        scores = torch.where(cmask[None, None], scores, -1e9)
        p = _softmax(scores, axis=-1)
        ctx = torch.einsum("bhqk,bhkd->bhqd", p, v)
        return torch.einsum("bhqd,hdm->bqm", ctx, w_o)

    a = _A_ref(A_x, A_k_cache, A_v_cache, A_wq, A_wo)
    b = _B_ref(B_x, B_c_kv, B_w_q, B_w_uk, B_w_uv, B_w_o)
    return torch.concatenate([a, b], axis=-1)
```

```asm
; @launch grid=(256,1,1) block=(512,1,1) lds=163840
.amdgcn_target "amdgcn-amd-amdhsa--gfx950"
.text
.globl concat_heads__sliding_block_cached__compressed_kv_cla__decode_kernel
.p2align 8
.type concat_heads__sliding_block_cached__compressed_kv_cla__decode_kernel,@function
concat_heads__sliding_block_cached__compressed_kv_cla__decode_kernel:
  s_cmp_ge_u32 s2, 256
  s_cbranch_scc1 L_EXIT
  s_load_dwordx16 s[36:51], s[0:1], 0
  s_load_dwordx8 s[52:59], s[0:1], 64
  s_load_dwordx4 s[60:63], s[0:1], 96
  v_lshrrev_b32 v2, 6, v0
  v_and_b32 v1, 63, v0
  v_readfirstlane_b32 s64, v2
  v_lshlrev_b32 v240, 4, v1
  v_lshlrev_b32 v241, 2, v1
  v_mov_b32 v246, -1
  v_mov_b32 v247, -1
  v_mov_b32 v248, -1
  v_mov_b32 v249, -1
  s_waitcnt lgkmcnt(0)
  s_mov_b32 s4, s62
  s_and_b32 s5, s63, 0xffff
  s_mov_b32 s6, 268435456
  s_mov_b32 s7, 0x00020000
  s_mov_b32 s68, s60
  s_and_b32 s69, s61, 0xffff
  s_mov_b32 s70, 256
  s_mov_b32 s71, 0x00020000
  s_cmp_lt_u32 s2, 128
  s_cbranch_scc1 L_BPATH
  s_sub_u32 s65, s2, 128
  s_and_b32 s82, s65, 7
  s_lshl_b32 s82, s82, 4
  s_lshr_b32 s28, s65, 3
  s_add_u32 s82, s82, s28
  s_lshr_b32 s77, s82, 2
  s_and_b32 s78, s82, 3
  v_lshlrev_b32 v5, 2, v0
  s_lshl_b32 s28, s65, 11
  s_add_u32 s28, s28, 262144
  buffer_store_dword v246, v5, s[4:7], s28 offen sc1
  v_lshrrev_b32 v7, 8, v0
  v_lshlrev_b32 v7, 18, v7
  v_bfe_u32 v8, v0, 4, 4
  v_lshl_add_u32 v7, v8, 14, v7
  v_and_b32 v8, 15, v0
  v_lshl_add_u32 v7, v8, 3, v7
  s_lshl_b32 s34, s65, 7
  s_add_u32 s34, s34, 1048576
  buffer_store_dwordx2 v[246:247], v7, s[4:7], s34 offen sc1
  s_lshl_b32 s28, s78, 7
  s_lshl_b32 s29, s64, 4
  s_add_u32 s28, s28, s29
  s_lshl_b32 s28, s28, 1
  s_lshl_b32 s29, s77, 10
  s_add_u32 s28, s28, s29
  s_add_u32 s28, s28, 65536
  s_add_u32 s29, s28, 32768
  v_lshrrev_b32 v7, 4, v1
  v_and_b32 v6, 15, v1
  v_lshlrev_b32 v6, 3, v6
  v_lshl_add_u32 v6, v7, 1, v6
  v_and_b32 v7, 1, v7
  v_lshlrev_b32 v7, 2, v7
  v_and_b32 v8, 15, v1
  v_add_u32 v7, v7, v8
  v_cmp_gt_u32 vcc, 4, v7
  s_and_saveexec_b64 s[72:73], vcc
  buffer_store_dword v246, v6, s[4:7], s28 offen sc1
  buffer_store_dword v246, v6, s[4:7], s29 offen sc1
  s_mov_b64 exec, s[72:73]
  s_cmp_lg_u32 s64, 0
  s_cbranch_scc1 L_s1a_clr_1
  s_lshl_b32 s28, s65, 5
  s_add_u32 s28, s28, 524288
  v_cmp_gt_u32 vcc, 8, v1
  s_and_saveexec_b64 s[72:73], vcc
  buffer_store_dword v246, v241, s[4:7], s28 offen sc1
  s_mov_b64 exec, s[72:73]
  v_lshrrev_b32 v2, 4, v1
  v_lshlrev_b32 v2, 13, v2
  v_and_b32 v3, 15, v1
  v_lshl_add_u32 v2, v3, 2, v2
  s_lshl_b32 s28, s82, 6
  v_cmp_gt_u32 vcc, 32, v1
  s_and_saveexec_b64 s[72:73], vcc
  buffer_store_dword v246, v2, s[4:7], s28 offen offset:0 sc1
  s_add_u32 s28, s28, 32768
  buffer_store_dword v246, v2, s[4:7], s28 offen sc1
  s_mov_b64 exec, s[72:73]
L_s1a_clr_1:
  v_lshrrev_b32 v2, 2, v1
  v_and_b32 v3, 3, v1
  v_lshlrev_b32 v4, 15, v2
  v_lshl_add_u32 v4, v3, 4, v4
  s_lshl_b32 s29, s64, 7
  v_lshlrev_b32 v5, 3, v2
  v_add_u32 v5, s29, v5
  s_mov_b32 s8, s50
  s_and_b32 s9, s51, 0xffff
  s_mov_b32 s10, 4194304
  s_mov_b32 s11, 0x00020000
  s_mov_b32 s12, s46
  s_and_b32 s13, s47, 0xffff
  s_mov_b32 s14, 2048
  s_mov_b32 s15, 0x00020000
  buffer_load_dwordx2 v[8:9], v5, s[12:15], 0 offen
  buffer_load_dwordx2 v[10:11], v5, s[12:15], 0 offen offset:1024
  s_lshl_b32 s28, s82, 6
  s_lshl_b32 s29, s64, 19
  s_add_u32 s28, s28, s29
  buffer_load_dwordx4 v[64:67], v4, s[8:11], s28 offen nt
  s_add_u32 s28, s28, 8192
  buffer_load_dwordx4 v[68:71], v4, s[8:11], s28 offen nt
  s_add_u32 s28, s28, 8192
  buffer_load_dwordx4 v[72:75], v4, s[8:11], s28 offen nt
  s_add_u32 s28, s28, 8192
  buffer_load_dwordx4 v[76:79], v4, s[8:11], s28 offen nt
  s_waitcnt vmcnt(6)
  s_barrier
  s_cmp_lg_u32 s64, 0
  s_cbranch_scc1 L_s1a_bit4_2
  v_mov_b32 v250, s2
  v_mov_b32 v251, 0x10
  v_cmp_gt_u32 vcc, 1, v1
  s_and_saveexec_b64 s[72:73], vcc
  buffer_store_byte v251, v250, s[68:71], 0 offen sc1
  s_mov_b64 exec, s[72:73]
L_s1a_bit4_2:
  v_mov_b32 v32, 0
  v_mov_b32 v33, 0
  v_mov_b32 v34, 0
  v_mov_b32 v35, 0
  v_mov_b32 v36, 0
  v_mov_b32 v37, 0
  v_mov_b32 v38, 0
  v_mov_b32 v39, 0
  v_mov_b32 v40, 0
  v_mov_b32 v41, 0
  v_mov_b32 v42, 0
  v_mov_b32 v43, 0
  v_mov_b32 v44, 0
  v_mov_b32 v45, 0
  v_mov_b32 v46, 0
  v_mov_b32 v47, 0
  s_waitcnt vmcnt(4)
  v_lshlrev_b32 v12, 16, v8
  v_and_b32 v13, 0xffff0000, v8
  v_lshlrev_b32 v14, 16, v9
  v_and_b32 v15, 0xffff0000, v9
  v_lshlrev_b32 v16, 16, v10
  v_and_b32 v17, 0xffff0000, v10
  v_lshlrev_b32 v18, 16, v11
  v_and_b32 v19, 0xffff0000, v11
  s_waitcnt vmcnt(3)
  v_lshlrev_b32 v20, 16, v64
  v_and_b32 v21, 0xffff0000, v64
  v_fmac_f32 v32, v20, v12
  v_fmac_f32 v33, v21, v12
  v_fmac_f32 v40, v20, v16
  v_fmac_f32 v41, v21, v16
  v_lshlrev_b32 v20, 16, v65
  v_and_b32 v21, 0xffff0000, v65
  v_fmac_f32 v34, v20, v12
  v_fmac_f32 v35, v21, v12
  v_fmac_f32 v42, v20, v16
  v_fmac_f32 v43, v21, v16
  v_lshlrev_b32 v20, 16, v66
  v_and_b32 v21, 0xffff0000, v66
  v_fmac_f32 v36, v20, v12
  v_fmac_f32 v37, v21, v12
  v_fmac_f32 v44, v20, v16
  v_fmac_f32 v45, v21, v16
  v_lshlrev_b32 v20, 16, v67
  v_and_b32 v21, 0xffff0000, v67
  v_fmac_f32 v38, v20, v12
  v_fmac_f32 v39, v21, v12
  v_fmac_f32 v46, v20, v16
  v_fmac_f32 v47, v21, v16
  s_waitcnt vmcnt(2)
  v_lshlrev_b32 v20, 16, v68
  v_and_b32 v21, 0xffff0000, v68
  v_fmac_f32 v32, v20, v13
  v_fmac_f32 v33, v21, v13
  v_fmac_f32 v40, v20, v17
  v_fmac_f32 v41, v21, v17
  v_lshlrev_b32 v20, 16, v69
  v_and_b32 v21, 0xffff0000, v69
  v_fmac_f32 v34, v20, v13
  v_fmac_f32 v35, v21, v13
  v_fmac_f32 v42, v20, v17
  v_fmac_f32 v43, v21, v17
  v_lshlrev_b32 v20, 16, v70
  v_and_b32 v21, 0xffff0000, v70
  v_fmac_f32 v36, v20, v13
  v_fmac_f32 v37, v21, v13
  v_fmac_f32 v44, v20, v17
  v_fmac_f32 v45, v21, v17
  v_lshlrev_b32 v20, 16, v71
  v_and_b32 v21, 0xffff0000, v71
  v_fmac_f32 v38, v20, v13
  v_fmac_f32 v39, v21, v13
  v_fmac_f32 v46, v20, v17
  v_fmac_f32 v47, v21, v17
  s_waitcnt vmcnt(1)
  v_lshlrev_b32 v20, 16, v72
  v_and_b32 v21, 0xffff0000, v72
  v_fmac_f32 v32, v20, v14
  v_fmac_f32 v33, v21, v14
  v_fmac_f32 v40, v20, v18
  v_fmac_f32 v41, v21, v18
  v_lshlrev_b32 v20, 16, v73
  v_and_b32 v21, 0xffff0000, v73
  v_fmac_f32 v34, v20, v14
  v_fmac_f32 v35, v21, v14
  v_fmac_f32 v42, v20, v18
  v_fmac_f32 v43, v21, v18
  v_lshlrev_b32 v20, 16, v74
  v_and_b32 v21, 0xffff0000, v74
  v_fmac_f32 v36, v20, v14
  v_fmac_f32 v37, v21, v14
  v_fmac_f32 v44, v20, v18
  v_fmac_f32 v45, v21, v18
  v_lshlrev_b32 v20, 16, v75
  v_and_b32 v21, 0xffff0000, v75
  v_fmac_f32 v38, v20, v14
  v_fmac_f32 v39, v21, v14
  v_fmac_f32 v46, v20, v18
  v_fmac_f32 v47, v21, v18
  s_waitcnt vmcnt(0)
  v_lshlrev_b32 v20, 16, v76
  v_and_b32 v21, 0xffff0000, v76
  v_fmac_f32 v32, v20, v15
  v_fmac_f32 v33, v21, v15
  v_fmac_f32 v40, v20, v19
  v_fmac_f32 v41, v21, v19
  v_lshlrev_b32 v20, 16, v77
  v_and_b32 v21, 0xffff0000, v77
  v_fmac_f32 v34, v20, v15
  v_fmac_f32 v35, v21, v15
  v_fmac_f32 v42, v20, v19
  v_fmac_f32 v43, v21, v19
  v_lshlrev_b32 v20, 16, v78
  v_and_b32 v21, 0xffff0000, v78
  v_fmac_f32 v36, v20, v15
  v_fmac_f32 v37, v21, v15
  v_fmac_f32 v44, v20, v19
  v_fmac_f32 v45, v21, v19
  v_lshlrev_b32 v20, 16, v79
  v_and_b32 v21, 0xffff0000, v79
  v_fmac_f32 v38, v20, v15
  v_fmac_f32 v39, v21, v15
  v_fmac_f32 v46, v20, v19
  v_fmac_f32 v47, v21, v19
  s_nop 1
  v_add_f32_dpp v32, v32, v32 row_ror:4 row_mask:0xf bank_mask:0xf
  v_add_f32_dpp v33, v33, v33 row_ror:4 row_mask:0xf bank_mask:0xf
  v_add_f32_dpp v34, v34, v34 row_ror:4 row_mask:0xf bank_mask:0xf
  v_add_f32_dpp v35, v35, v35 row_ror:4 row_mask:0xf bank_mask:0xf
  v_add_f32_dpp v36, v36, v36 row_ror:4 row_mask:0xf bank_mask:0xf
  v_add_f32_dpp v37, v37, v37 row_ror:4 row_mask:0xf bank_mask:0xf
  v_add_f32_dpp v38, v38, v38 row_ror:4 row_mask:0xf bank_mask:0xf
  v_add_f32_dpp v39, v39, v39 row_ror:4 row_mask:0xf bank_mask:0xf
  v_add_f32_dpp v40, v40, v40 row_ror:4 row_mask:0xf bank_mask:0xf
  v_add_f32_dpp v41, v41, v41 row_ror:4 row_mask:0xf bank_mask:0xf
  v_add_f32_dpp v42, v42, v42 row_ror:4 row_mask:0xf bank_mask:0xf
  v_add_f32_dpp v43, v43, v43 row_ror:4 row_mask:0xf bank_mask:0xf
  v_add_f32_dpp v44, v44, v44 row_ror:4 row_mask:0xf bank_mask:0xf
  v_add_f32_dpp v45, v45, v45 row_ror:4 row_mask:0xf bank_mask:0xf
  v_add_f32_dpp v46, v46, v46 row_ror:4 row_mask:0xf bank_mask:0xf
  v_add_f32_dpp v47, v47, v47 row_ror:4 row_mask:0xf bank_mask:0xf
  v_add_f32_dpp v32, v32, v32 row_ror:8 row_mask:0xf bank_mask:0xf
  v_add_f32_dpp v33, v33, v33 row_ror:8 row_mask:0xf bank_mask:0xf
  v_add_f32_dpp v34, v34, v34 row_ror:8 row_mask:0xf bank_mask:0xf
  v_add_f32_dpp v35, v35, v35 row_ror:8 row_mask:0xf bank_mask:0xf
  v_add_f32_dpp v36, v36, v36 row_ror:8 row_mask:0xf bank_mask:0xf
  v_add_f32_dpp v37, v37, v37 row_ror:8 row_mask:0xf bank_mask:0xf
  v_add_f32_dpp v38, v38, v38 row_ror:8 row_mask:0xf bank_mask:0xf
  v_add_f32_dpp v39, v39, v39 row_ror:8 row_mask:0xf bank_mask:0xf
  v_add_f32_dpp v40, v40, v40 row_ror:8 row_mask:0xf bank_mask:0xf
  v_add_f32_dpp v41, v41, v41 row_ror:8 row_mask:0xf bank_mask:0xf
  v_add_f32_dpp v42, v42, v42 row_ror:8 row_mask:0xf bank_mask:0xf
  v_add_f32_dpp v43, v43, v43 row_ror:8 row_mask:0xf bank_mask:0xf
  v_add_f32_dpp v44, v44, v44 row_ror:8 row_mask:0xf bank_mask:0xf
  v_add_f32_dpp v45, v45, v45 row_ror:8 row_mask:0xf bank_mask:0xf
  v_add_f32_dpp v46, v46, v46 row_ror:8 row_mask:0xf bank_mask:0xf
  v_add_f32_dpp v47, v47, v47 row_ror:8 row_mask:0xf bank_mask:0xf
  v_mov_b32 v48, v32
  v_mov_b32 v49, v33
  v_mov_b32 v50, v34
  v_mov_b32 v51, v35
  v_mov_b32 v52, v36
  v_mov_b32 v53, v37
  v_mov_b32 v54, v38
  v_mov_b32 v55, v39
  v_mov_b32 v56, v40
  v_mov_b32 v57, v41
  v_mov_b32 v58, v42
  v_mov_b32 v59, v43
  v_mov_b32 v60, v44
  v_mov_b32 v61, v45
  v_mov_b32 v62, v46
  v_mov_b32 v63, v47
  v_permlane16_swap_b32 v32, v48
  v_permlane16_swap_b32 v33, v49
  v_permlane16_swap_b32 v34, v50
  v_permlane16_swap_b32 v35, v51
  v_permlane16_swap_b32 v36, v52
  v_permlane16_swap_b32 v37, v53
  v_permlane16_swap_b32 v38, v54
  v_permlane16_swap_b32 v39, v55
  v_permlane16_swap_b32 v40, v56
  v_permlane16_swap_b32 v41, v57
  v_permlane16_swap_b32 v42, v58
  v_permlane16_swap_b32 v43, v59
  v_permlane16_swap_b32 v44, v60
  v_permlane16_swap_b32 v45, v61
  v_permlane16_swap_b32 v46, v62
  v_permlane16_swap_b32 v47, v63
  v_add_f32 v32, v32, v48
  v_add_f32 v33, v33, v49
  v_add_f32 v34, v34, v50
  v_add_f32 v35, v35, v51
  v_add_f32 v36, v36, v52
  v_add_f32 v37, v37, v53
  v_add_f32 v38, v38, v54
  v_add_f32 v39, v39, v55
  v_add_f32 v40, v40, v56
  v_add_f32 v41, v41, v57
  v_add_f32 v42, v42, v58
  v_add_f32 v43, v43, v59
  v_add_f32 v44, v44, v60
  v_add_f32 v45, v45, v61
  v_add_f32 v46, v46, v62
  v_add_f32 v47, v47, v63
  v_mov_b32 v48, v32
  v_mov_b32 v49, v33
  v_mov_b32 v50, v34
  v_mov_b32 v51, v35
  v_mov_b32 v52, v36
  v_mov_b32 v53, v37
  v_mov_b32 v54, v38
  v_mov_b32 v55, v39
  v_mov_b32 v56, v40
  v_mov_b32 v57, v41
  v_mov_b32 v58, v42
  v_mov_b32 v59, v43
  v_mov_b32 v60, v44
  v_mov_b32 v61, v45
  v_mov_b32 v62, v46
  v_mov_b32 v63, v47
  v_permlane32_swap_b32 v32, v48
  v_permlane32_swap_b32 v33, v49
  v_permlane32_swap_b32 v34, v50
  v_permlane32_swap_b32 v35, v51
  v_permlane32_swap_b32 v36, v52
  v_permlane32_swap_b32 v37, v53
  v_permlane32_swap_b32 v38, v54
  v_permlane32_swap_b32 v39, v55
  v_permlane32_swap_b32 v40, v56
  v_permlane32_swap_b32 v41, v57
  v_permlane32_swap_b32 v42, v58
  v_permlane32_swap_b32 v43, v59
  v_permlane32_swap_b32 v44, v60
  v_permlane32_swap_b32 v45, v61
  v_permlane32_swap_b32 v46, v62
  v_permlane32_swap_b32 v47, v63
  v_add_f32 v32, v32, v48
  v_add_f32 v33, v33, v49
  v_add_f32 v34, v34, v50
  v_add_f32 v35, v35, v51
  v_add_f32 v36, v36, v52
  v_add_f32 v37, v37, v53
  v_add_f32 v38, v38, v54
  v_add_f32 v39, v39, v55
  v_add_f32 v40, v40, v56
  v_add_f32 v41, v41, v57
  v_add_f32 v42, v42, v58
  v_add_f32 v43, v43, v59
  v_add_f32 v44, v44, v60
  v_add_f32 v45, v45, v61
  v_add_f32 v46, v46, v62
  v_add_f32 v47, v47, v63
  s_lshl_b32 s29, s64, 8
  v_lshlrev_b32 v6, 6, v1
  v_add_u32 v6, s29, v6
  v_cmp_gt_u32 vcc, 4, v1
  s_and_saveexec_b64 s[72:73], vcc
  ds_write_b128 v6, v[32:35] offset:0
  ds_write_b128 v6, v[36:39] offset:16
  ds_write_b128 v6, v[40:43] offset:32
  ds_write_b128 v6, v[44:47] offset:48
  s_mov_b64 exec, s[72:73]
  s_waitcnt lgkmcnt(0)
  s_barrier
  s_cmp_lg_u32 s64, 0
  s_cbranch_scc1 L_proj_skip_3
  v_and_b32 v22, 31, v1
  v_lshrrev_b32 v23, 5, v1
  v_lshrrev_b32 v24, 3, v22
  v_lshlrev_b32 v24, 6, v24
  v_and_b32 v25, 7, v22
  v_lshl_add_u32 v25, v23, 3, v25
  v_lshl_add_u32 v24, v25, 2, v24
  ds_read_b32 v48, v24 offset:0
  ds_read_b32 v49, v24 offset:256
  ds_read_b32 v50, v24 offset:512
  ds_read_b32 v51, v24 offset:768
  ds_read_b32 v52, v24 offset:1024
  ds_read_b32 v53, v24 offset:1280
  ds_read_b32 v54, v24 offset:1536
  ds_read_b32 v55, v24 offset:1792
  s_waitcnt lgkmcnt(0)
  v_add_f32 v48, v48, v49
  v_add_f32 v50, v50, v51
  v_add_f32 v52, v52, v53
  v_add_f32 v54, v54, v55
  v_add_f32 v48, v48, v50
  v_add_f32 v52, v52, v54
  v_add_f32 v48, v48, v52
  v_cvt_pk_bf16_f32 v48, v48, v48
  s_nop 1
  v_mov_b32_dpp v49, v48 quad_perm:[1,0,3,2] row_mask:0xf bank_mask:0xf
  v_and_b32 v48, 0xffff, v48
  v_lshl_or_b32 v48, v49, 16, v48
  s_lshl_b32 s29, s82, 6
  s_add_u32 s29, s29, 32768
  v_lshlrev_b32 v6, 13, v23
  v_lshl_add_u32 v6, v22, 1, v6
  v_and_b32 v25, 1, v1
  v_cmp_eq_u32 vcc, 0, v25
  s_and_saveexec_b64 s[72:73], vcc
  buffer_store_dword v48, v6, s[4:7], s29 offen sc1
  s_mov_b64 exec, s[72:73]
L_proj_skip_3:
  s_mov_b32 s16, s52
  s_and_b32 s17, s53, 0xffff
  s_mov_b32 s18, 4194304
  s_mov_b32 s19, 0x00020000
  v_lshrrev_b32 v22, 4, v1
  v_and_b32 v23, 15, v1
  v_lshlrev_b32 v6, 13, v22
  v_lshl_add_u32 v6, v23, 4, v6
  s_lshl_b32 s28, s78, 7
  s_lshl_b32 s29, s64, 4
  s_add_u32 s28, s28, s29
  s_lshl_b32 s28, s28, 13
  s_lshl_b32 s29, s77, 8
  s_add_u32 s28, s28, s29
  buffer_load_dwordx4 v[128:131], v6, s[16:19], s28 offen nt
  s_add_u32 s28, s28, 32768
  buffer_load_dwordx4 v[132:135], v6, s[16:19], s28 offen nt
  s_add_u32 s28, s28, 32768
  buffer_load_dwordx4 v[136:139], v6, s[16:19], s28 offen nt
  s_add_u32 s28, s28, 32768
  buffer_load_dwordx4 v[140:143], v6, s[16:19], s28 offen nt
  s_mov_b32 s8, s42
  s_and_b32 s9, s43, 0xffff
  s_mov_b32 s10, 4194304
  s_mov_b32 s11, 0x00020000
  s_mov_b32 s12, s36
  s_and_b32 s13, s37, 0xffff
  s_mov_b32 s14, 2048
  s_mov_b32 s15, 0x00020000
  buffer_load_dwordx2 v[160:161], v5, s[12:15], 0 offen
  buffer_load_dwordx2 v[162:163], v5, s[12:15], 0 offen offset:1024
  s_lshl_b32 s28, s82, 6
  s_lshl_b32 s29, s64, 19
  s_add_u32 s28, s28, s29
  buffer_load_dwordx4 v[80:83], v4, s[8:11], s28 offen nt
  s_add_u32 s28, s28, 8192
  buffer_load_dwordx4 v[84:87], v4, s[8:11], s28 offen nt
  s_add_u32 s28, s28, 8192
  buffer_load_dwordx4 v[88:91], v4, s[8:11], s28 offen nt
  s_add_u32 s28, s28, 8192
  buffer_load_dwordx4 v[92:95], v4, s[8:11], s28 offen nt
  v_mov_b32 v32, 0
  v_mov_b32 v33, 0
  v_mov_b32 v34, 0
  v_mov_b32 v35, 0
  v_mov_b32 v36, 0
  v_mov_b32 v37, 0
  v_mov_b32 v38, 0
  v_mov_b32 v39, 0
  v_mov_b32 v40, 0
  v_mov_b32 v41, 0
  v_mov_b32 v42, 0
  v_mov_b32 v43, 0
  v_mov_b32 v44, 0
  v_mov_b32 v45, 0
  v_mov_b32 v46, 0
  v_mov_b32 v47, 0
  s_waitcnt vmcnt(4)
  v_lshlrev_b32 v12, 16, v160
  v_and_b32 v13, 0xffff0000, v160
  v_lshlrev_b32 v14, 16, v161
  v_and_b32 v15, 0xffff0000, v161
  v_lshlrev_b32 v16, 16, v162
  v_and_b32 v17, 0xffff0000, v162
  v_lshlrev_b32 v18, 16, v163
  v_and_b32 v19, 0xffff0000, v163
  s_waitcnt vmcnt(3)
  v_lshlrev_b32 v20, 16, v80
  v_and_b32 v21, 0xffff0000, v80
  v_fmac_f32 v32, v20, v12
  v_fmac_f32 v33, v21, v12
  v_fmac_f32 v40, v20, v16
  v_fmac_f32 v41, v21, v16
  v_lshlrev_b32 v20, 16, v81
  v_and_b32 v21, 0xffff0000, v81
  v_fmac_f32 v34, v20, v12
  v_fmac_f32 v35, v21, v12
  v_fmac_f32 v42, v20, v16
  v_fmac_f32 v43, v21, v16
  v_lshlrev_b32 v20, 16, v82
  v_and_b32 v21, 0xffff0000, v82
  v_fmac_f32 v36, v20, v12
  v_fmac_f32 v37, v21, v12
  v_fmac_f32 v44, v20, v16
  v_fmac_f32 v45, v21, v16
  v_lshlrev_b32 v20, 16, v83
  v_and_b32 v21, 0xffff0000, v83
  v_fmac_f32 v38, v20, v12
  v_fmac_f32 v39, v21, v12
  v_fmac_f32 v46, v20, v16
  v_fmac_f32 v47, v21, v16
  s_waitcnt vmcnt(2)
  v_lshlrev_b32 v20, 16, v84
  v_and_b32 v21, 0xffff0000, v84
  v_fmac_f32 v32, v20, v13
  v_fmac_f32 v33, v21, v13
  v_fmac_f32 v40, v20, v17
  v_fmac_f32 v41, v21, v17
  v_lshlrev_b32 v20, 16, v85
  v_and_b32 v21, 0xffff0000, v85
  v_fmac_f32 v34, v20, v13
  v_fmac_f32 v35, v21, v13
  v_fmac_f32 v42, v20, v17
  v_fmac_f32 v43, v21, v17
  v_lshlrev_b32 v20, 16, v86
  v_and_b32 v21, 0xffff0000, v86
  v_fmac_f32 v36, v20, v13
  v_fmac_f32 v37, v21, v13
  v_fmac_f32 v44, v20, v17
  v_fmac_f32 v45, v21, v17
  v_lshlrev_b32 v20, 16, v87
  v_and_b32 v21, 0xffff0000, v87
  v_fmac_f32 v38, v20, v13
  v_fmac_f32 v39, v21, v13
  v_fmac_f32 v46, v20, v17
  v_fmac_f32 v47, v21, v17
  s_waitcnt vmcnt(1)
  v_lshlrev_b32 v20, 16, v88
  v_and_b32 v21, 0xffff0000, v88
  v_fmac_f32 v32, v20, v14
  v_fmac_f32 v33, v21, v14
  v_fmac_f32 v40, v20, v18
  v_fmac_f32 v41, v21, v18
  v_lshlrev_b32 v20, 16, v89
  v_and_b32 v21, 0xffff0000, v89
  v_fmac_f32 v34, v20, v14
  v_fmac_f32 v35, v21, v14
  v_fmac_f32 v42, v20, v18
  v_fmac_f32 v43, v21, v18
  v_lshlrev_b32 v20, 16, v90
  v_and_b32 v21, 0xffff0000, v90
  v_fmac_f32 v36, v20, v14
  v_fmac_f32 v37, v21, v14
  v_fmac_f32 v44, v20, v18
  v_fmac_f32 v45, v21, v18
  v_lshlrev_b32 v20, 16, v91
  v_and_b32 v21, 0xffff0000, v91
  v_fmac_f32 v38, v20, v14
  v_fmac_f32 v39, v21, v14
  v_fmac_f32 v46, v20, v18
  v_fmac_f32 v47, v21, v18
  s_waitcnt vmcnt(0)
  v_lshlrev_b32 v20, 16, v92
  v_and_b32 v21, 0xffff0000, v92
  v_fmac_f32 v32, v20, v15
  v_fmac_f32 v33, v21, v15
  v_fmac_f32 v40, v20, v19
  v_fmac_f32 v41, v21, v19
  v_lshlrev_b32 v20, 16, v93
  v_and_b32 v21, 0xffff0000, v93
  v_fmac_f32 v34, v20, v15
  v_fmac_f32 v35, v21, v15
  v_fmac_f32 v42, v20, v19
  v_fmac_f32 v43, v21, v19
  v_lshlrev_b32 v20, 16, v94
  v_and_b32 v21, 0xffff0000, v94
  v_fmac_f32 v36, v20, v15
  v_fmac_f32 v37, v21, v15
  v_fmac_f32 v44, v20, v19
  v_fmac_f32 v45, v21, v19
  v_lshlrev_b32 v20, 16, v95
  v_and_b32 v21, 0xffff0000, v95
  v_fmac_f32 v38, v20, v15
  v_fmac_f32 v39, v21, v15
  v_fmac_f32 v46, v20, v19
  v_fmac_f32 v47, v21, v19
  s_nop 1
  v_add_f32_dpp v32, v32, v32 row_ror:4 row_mask:0xf bank_mask:0xf
  v_add_f32_dpp v33, v33, v33 row_ror:4 row_mask:0xf bank_mask:0xf
  v_add_f32_dpp v34, v34, v34 row_ror:4 row_mask:0xf bank_mask:0xf
  v_add_f32_dpp v35, v35, v35 row_ror:4 row_mask:0xf bank_mask:0xf
  v_add_f32_dpp v36, v36, v36 row_ror:4 row_mask:0xf bank_mask:0xf
  v_add_f32_dpp v37, v37, v37 row_ror:4 row_mask:0xf bank_mask:0xf
  v_add_f32_dpp v38, v38, v38 row_ror:4 row_mask:0xf bank_mask:0xf
  v_add_f32_dpp v39, v39, v39 row_ror:4 row_mask:0xf bank_mask:0xf
  v_add_f32_dpp v40, v40, v40 row_ror:4 row_mask:0xf bank_mask:0xf
  v_add_f32_dpp v41, v41, v41 row_ror:4 row_mask:0xf bank_mask:0xf
  v_add_f32_dpp v42, v42, v42 row_ror:4 row_mask:0xf bank_mask:0xf
  v_add_f32_dpp v43, v43, v43 row_ror:4 row_mask:0xf bank_mask:0xf
  v_add_f32_dpp v44, v44, v44 row_ror:4 row_mask:0xf bank_mask:0xf
  v_add_f32_dpp v45, v45, v45 row_ror:4 row_mask:0xf bank_mask:0xf
  v_add_f32_dpp v46, v46, v46 row_ror:4 row_mask:0xf bank_mask:0xf
  v_add_f32_dpp v47, v47, v47 row_ror:4 row_mask:0xf bank_mask:0xf
  v_add_f32_dpp v32, v32, v32 row_ror:8 row_mask:0xf bank_mask:0xf
  v_add_f32_dpp v33, v33, v33 row_ror:8 row_mask:0xf bank_mask:0xf
  v_add_f32_dpp v34, v34, v34 row_ror:8 row_mask:0xf bank_mask:0xf
  v_add_f32_dpp v35, v35, v35 row_ror:8 row_mask:0xf bank_mask:0xf
  v_add_f32_dpp v36, v36, v36 row_ror:8 row_mask:0xf bank_mask:0xf
  v_add_f32_dpp v37, v37, v37 row_ror:8 row_mask:0xf bank_mask:0xf
  v_add_f32_dpp v38, v38, v38 row_ror:8 row_mask:0xf bank_mask:0xf
  v_add_f32_dpp v39, v39, v39 row_ror:8 row_mask:0xf bank_mask:0xf
  v_add_f32_dpp v40, v40, v40 row_ror:8 row_mask:0xf bank_mask:0xf
  v_add_f32_dpp v41, v41, v41 row_ror:8 row_mask:0xf bank_mask:0xf
  v_add_f32_dpp v42, v42, v42 row_ror:8 row_mask:0xf bank_mask:0xf
  v_add_f32_dpp v43, v43, v43 row_ror:8 row_mask:0xf bank_mask:0xf
  v_add_f32_dpp v44, v44, v44 row_ror:8 row_mask:0xf bank_mask:0xf
  v_add_f32_dpp v45, v45, v45 row_ror:8 row_mask:0xf bank_mask:0xf
  v_add_f32_dpp v46, v46, v46 row_ror:8 row_mask:0xf bank_mask:0xf
  v_add_f32_dpp v47, v47, v47 row_ror:8 row_mask:0xf bank_mask:0xf
  v_mov_b32 v48, v32
  v_mov_b32 v49, v33
  v_mov_b32 v50, v34
  v_mov_b32 v51, v35
  v_mov_b32 v52, v36
  v_mov_b32 v53, v37
  v_mov_b32 v54, v38
  v_mov_b32 v55, v39
  v_mov_b32 v56, v40
  v_mov_b32 v57, v41
  v_mov_b32 v58, v42
  v_mov_b32 v59, v43
  v_mov_b32 v60, v44
  v_mov_b32 v61, v45
  v_mov_b32 v62, v46
  v_mov_b32 v63, v47
  v_permlane16_swap_b32 v32, v48
  v_permlane16_swap_b32 v33, v49
  v_permlane16_swap_b32 v34, v50
  v_permlane16_swap_b32 v35, v51
  v_permlane16_swap_b32 v36, v52
  v_permlane16_swap_b32 v37, v53
  v_permlane16_swap_b32 v38, v54
  v_permlane16_swap_b32 v39, v55
  v_permlane16_swap_b32 v40, v56
  v_permlane16_swap_b32 v41, v57
  v_permlane16_swap_b32 v42, v58
  v_permlane16_swap_b32 v43, v59
  v_permlane16_swap_b32 v44, v60
  v_permlane16_swap_b32 v45, v61
  v_permlane16_swap_b32 v46, v62
  v_permlane16_swap_b32 v47, v63
  v_add_f32 v32, v32, v48
  v_add_f32 v33, v33, v49
  v_add_f32 v34, v34, v50
  v_add_f32 v35, v35, v51
  v_add_f32 v36, v36, v52
  v_add_f32 v37, v37, v53
  v_add_f32 v38, v38, v54
  v_add_f32 v39, v39, v55
  v_add_f32 v40, v40, v56
  v_add_f32 v41, v41, v57
  v_add_f32 v42, v42, v58
  v_add_f32 v43, v43, v59
  v_add_f32 v44, v44, v60
  v_add_f32 v45, v45, v61
  v_add_f32 v46, v46, v62
  v_add_f32 v47, v47, v63
  v_mov_b32 v48, v32
  v_mov_b32 v49, v33
  v_mov_b32 v50, v34
  v_mov_b32 v51, v35
  v_mov_b32 v52, v36
  v_mov_b32 v53, v37
  v_mov_b32 v54, v38
  v_mov_b32 v55, v39
  v_mov_b32 v56, v40
  v_mov_b32 v57, v41
  v_mov_b32 v58, v42
  v_mov_b32 v59, v43
  v_mov_b32 v60, v44
  v_mov_b32 v61, v45
  v_mov_b32 v62, v46
  v_mov_b32 v63, v47
  v_permlane32_swap_b32 v32, v48
  v_permlane32_swap_b32 v33, v49
  v_permlane32_swap_b32 v34, v50
  v_permlane32_swap_b32 v35, v51
  v_permlane32_swap_b32 v36, v52
  v_permlane32_swap_b32 v37, v53
  v_permlane32_swap_b32 v38, v54
  v_permlane32_swap_b32 v39, v55
  v_permlane32_swap_b32 v40, v56
  v_permlane32_swap_b32 v41, v57
  v_permlane32_swap_b32 v42, v58
  v_permlane32_swap_b32 v43, v59
  v_permlane32_swap_b32 v44, v60
  v_permlane32_swap_b32 v45, v61
  v_permlane32_swap_b32 v46, v62
  v_permlane32_swap_b32 v47, v63
  v_add_f32 v32, v32, v48
  v_add_f32 v33, v33, v49
  v_add_f32 v34, v34, v50
  v_add_f32 v35, v35, v51
  v_add_f32 v36, v36, v52
  v_add_f32 v37, v37, v53
  v_add_f32 v38, v38, v54
  v_add_f32 v39, v39, v55
  v_add_f32 v40, v40, v56
  v_add_f32 v41, v41, v57
  v_add_f32 v42, v42, v58
  v_add_f32 v43, v43, v59
  v_add_f32 v44, v44, v60
  v_add_f32 v45, v45, v61
  v_add_f32 v46, v46, v62
  v_add_f32 v47, v47, v63
  s_lshl_b32 s29, s64, 8
  v_lshlrev_b32 v6, 6, v1
  v_add_u32 v6, s29, v6
  v_cmp_gt_u32 vcc, 4, v1
  s_and_saveexec_b64 s[72:73], vcc
  ds_write_b128 v6, v[32:35] offset:2048
  ds_write_b128 v6, v[36:39] offset:2064
  ds_write_b128 v6, v[40:43] offset:2080
  ds_write_b128 v6, v[44:47] offset:2096
  s_mov_b64 exec, s[72:73]
  s_waitcnt lgkmcnt(0)
  s_barrier
  s_cmp_lg_u32 s64, 0
  s_cbranch_scc1 L_proj_skip_4
  v_and_b32 v22, 31, v1
  v_lshrrev_b32 v23, 5, v1
  v_lshrrev_b32 v24, 3, v22
  v_lshlrev_b32 v24, 6, v24
  v_and_b32 v25, 7, v22
  v_lshl_add_u32 v25, v23, 3, v25
  v_lshl_add_u32 v24, v25, 2, v24
  ds_read_b32 v48, v24 offset:2048
  ds_read_b32 v49, v24 offset:2304
  ds_read_b32 v50, v24 offset:2560
  ds_read_b32 v51, v24 offset:2816
  ds_read_b32 v52, v24 offset:3072
  ds_read_b32 v53, v24 offset:3328
  ds_read_b32 v54, v24 offset:3584
  ds_read_b32 v55, v24 offset:3840
  s_waitcnt lgkmcnt(0)
  v_add_f32 v48, v48, v49
  v_add_f32 v50, v50, v51
  v_add_f32 v52, v52, v53
  v_add_f32 v54, v54, v55
  v_add_f32 v48, v48, v50
  v_add_f32 v52, v52, v54
  v_add_f32 v48, v48, v52
  v_cvt_pk_bf16_f32 v48, v48, v48
  s_nop 1
  v_mov_b32_dpp v49, v48 quad_perm:[1,0,3,2] row_mask:0xf bank_mask:0xf
  v_and_b32 v48, 0xffff, v48
  v_lshl_or_b32 v48, v49, 16, v48
  s_lshl_b32 s29, s82, 6
  s_add_u32 s29, s29, 0
  v_lshlrev_b32 v6, 13, v23
  v_lshl_add_u32 v6, v22, 1, v6
  v_and_b32 v25, 1, v1
  v_cmp_eq_u32 vcc, 0, v25
  s_and_saveexec_b64 s[72:73], vcc
  buffer_store_dword v48, v6, s[4:7], s29 offen sc1
  s_mov_b64 exec, s[72:73]
L_proj_skip_4:
  v_lshrrev_b32 v2, 4, v1
  v_and_b32 v3, 15, v1
  v_lshlrev_b32 v4, 4, v3
  s_lshl_b32 s35, s77, 8
  s_add_u32 s35, s35, 32768
  s_mov_b32 s74, 0x8000
L_qb_tw_5:
  buffer_load_dwordx4 v[64:67], v4, s[4:7], s35 offen sc1
  s_add_u32 s28, s35, 8192
  buffer_load_dwordx4 v[68:71], v4, s[4:7], s28 offen sc1
  buffer_load_dword v244, v241, s[68:71], 0 offen sc1
  s_waitcnt vmcnt(0)
  v_max3_u32 v243, v64, v65, v66
  v_max3_u32 v243, v67, v68, v243
  v_max3_u32 v243, v69, v70, v243
  v_max_u32 v243, v71, v243
  v_and_b32 v244, 0x10101010, v244
  v_cmp_eq_u32 vcc, -1, v243
  s_mov_b64 s[98:99], vcc
  v_cmp_ne_u32 vcc, 0x10101010, v244
  s_or_b64 vcc, vcc, s[98:99]
  s_cmp_eq_u64 vcc, 0
  s_cbranch_scc1 L_qb_twd_6
  s_sleep 8
  s_sub_u32 s74, s74, 1
  s_cmp_lg_u32 s74, 0
  s_cbranch_scc1 L_qb_tw_5
L_qb_twd_6:
  v_lshlrev_b32 v144, 16, v64
  v_and_b32 v145, 0xffff0000, v64
  v_lshlrev_b32 v146, 16, v65
  v_and_b32 v147, 0xffff0000, v65
  v_lshlrev_b32 v148, 16, v66
  v_and_b32 v149, 0xffff0000, v66
  v_lshlrev_b32 v150, 16, v67
  v_and_b32 v151, 0xffff0000, v67
  v_lshlrev_b32 v152, 16, v68
  v_and_b32 v153, 0xffff0000, v68
  v_lshlrev_b32 v154, 16, v69
  v_and_b32 v155, 0xffff0000, v69
  v_lshlrev_b32 v156, 16, v70
  v_and_b32 v157, 0xffff0000, v70
  v_lshlrev_b32 v158, 16, v71
  v_and_b32 v159, 0xffff0000, v71
  v_lshlrev_b32 v30, 16, v128
  v_and_b32 v31, 0xffff0000, v128
  v_mul_f32 v28, v30, v144
  v_mul_f32 v29, v30, v152
  v_fmac_f32 v28, v31, v145
  v_fmac_f32 v29, v31, v153
  v_lshlrev_b32 v30, 16, v129
  v_and_b32 v31, 0xffff0000, v129
  v_fmac_f32 v28, v30, v146
  v_fmac_f32 v29, v30, v154
  v_fmac_f32 v28, v31, v147
  v_fmac_f32 v29, v31, v155
  v_lshlrev_b32 v30, 16, v130
  v_and_b32 v31, 0xffff0000, v130
  v_fmac_f32 v28, v30, v148
  v_fmac_f32 v29, v30, v156
  v_fmac_f32 v28, v31, v149
  v_fmac_f32 v29, v31, v157
  v_lshlrev_b32 v30, 16, v131
  v_and_b32 v31, 0xffff0000, v131
  v_fmac_f32 v28, v30, v150
  v_fmac_f32 v29, v30, v158
  v_fmac_f32 v28, v31, v151
  v_fmac_f32 v29, v31, v159
  s_nop 1
  v_add_f32_dpp v28, v28, v28 row_ror:1 row_mask:0xf bank_mask:0xf
  v_add_f32_dpp v29, v29, v29 row_ror:1 row_mask:0xf bank_mask:0xf
  s_nop 0
  v_add_f32_dpp v28, v28, v28 row_ror:2 row_mask:0xf bank_mask:0xf
  v_add_f32_dpp v29, v29, v29 row_ror:2 row_mask:0xf bank_mask:0xf
  s_nop 0
  v_add_f32_dpp v28, v28, v28 row_ror:4 row_mask:0xf bank_mask:0xf
  v_add_f32_dpp v29, v29, v29 row_ror:4 row_mask:0xf bank_mask:0xf
  s_nop 0
  v_add_f32_dpp v28, v28, v28 row_ror:8 row_mask:0xf bank_mask:0xf
  v_add_f32_dpp v29, v29, v29 row_ror:8 row_mask:0xf bank_mask:0xf
  s_nop 0
  v_cmp_eq_u32 vcc, 0, v3
  s_nop 1
  v_cndmask_b32 v32, v32, v28, vcc
  v_cndmask_b32 v33, v33, v29, vcc
  v_lshlrev_b32 v30, 16, v132
  v_and_b32 v31, 0xffff0000, v132
  v_mul_f32 v28, v30, v144
  v_mul_f32 v29, v30, v152
  v_fmac_f32 v28, v31, v145
  v_fmac_f32 v29, v31, v153
  v_lshlrev_b32 v30, 16, v133
  v_and_b32 v31, 0xffff0000, v133
  v_fmac_f32 v28, v30, v146
  v_fmac_f32 v29, v30, v154
  v_fmac_f32 v28, v31, v147
  v_fmac_f32 v29, v31, v155
  v_lshlrev_b32 v30, 16, v134
  v_and_b32 v31, 0xffff0000, v134
  v_fmac_f32 v28, v30, v148
  v_fmac_f32 v29, v30, v156
  v_fmac_f32 v28, v31, v149
  v_fmac_f32 v29, v31, v157
  v_lshlrev_b32 v30, 16, v135
  v_and_b32 v31, 0xffff0000, v135
  v_fmac_f32 v28, v30, v150
  v_fmac_f32 v29, v30, v158
  v_fmac_f32 v28, v31, v151
  v_fmac_f32 v29, v31, v159
  s_nop 1
  v_add_f32_dpp v28, v28, v28 row_ror:1 row_mask:0xf bank_mask:0xf
  v_add_f32_dpp v29, v29, v29 row_ror:1 row_mask:0xf bank_mask:0xf
  s_nop 0
  v_add_f32_dpp v28, v28, v28 row_ror:2 row_mask:0xf bank_mask:0xf
  v_add_f32_dpp v29, v29, v29 row_ror:2 row_mask:0xf bank_mask:0xf
  s_nop 0
  v_add_f32_dpp v28, v28, v28 row_ror:4 row_mask:0xf bank_mask:0xf
  v_add_f32_dpp v29, v29, v29 row_ror:4 row_mask:0xf bank_mask:0xf
  s_nop 0
  v_add_f32_dpp v28, v28, v28 row_ror:8 row_mask:0xf bank_mask:0xf
  v_add_f32_dpp v29, v29, v29 row_ror:8 row_mask:0xf bank_mask:0xf
  s_nop 0
  v_cmp_eq_u32 vcc, 1, v3
  s_nop 1
  v_cndmask_b32 v32, v32, v28, vcc
  v_cndmask_b32 v33, v33, v29, vcc
  v_lshlrev_b32 v30, 16, v136
  v_and_b32 v31, 0xffff0000, v136
  v_mul_f32 v28, v30, v144
  v_mul_f32 v29, v30, v152
  v_fmac_f32 v28, v31, v145
  v_fmac_f32 v29, v31, v153
  v_lshlrev_b32 v30, 16, v137
  v_and_b32 v31, 0xffff0000, v137
  v_fmac_f32 v28, v30, v146
  v_fmac_f32 v29, v30, v154
  v_fmac_f32 v28, v31, v147
  v_fmac_f32 v29, v31, v155
  v_lshlrev_b32 v30, 16, v138
  v_and_b32 v31, 0xffff0000, v138
  v_fmac_f32 v28, v30, v148
  v_fmac_f32 v29, v30, v156
  v_fmac_f32 v28, v31, v149
  v_fmac_f32 v29, v31, v157
  v_lshlrev_b32 v30, 16, v139
  v_and_b32 v31, 0xffff0000, v139
  v_fmac_f32 v28, v30, v150
  v_fmac_f32 v29, v30, v158
  v_fmac_f32 v28, v31, v151
  v_fmac_f32 v29, v31, v159
  s_nop 1
  v_add_f32_dpp v28, v28, v28 row_ror:1 row_mask:0xf bank_mask:0xf
  v_add_f32_dpp v29, v29, v29 row_ror:1 row_mask:0xf bank_mask:0xf
  s_nop 0
  v_add_f32_dpp v28, v28, v28 row_ror:2 row_mask:0xf bank_mask:0xf
  v_add_f32_dpp v29, v29, v29 row_ror:2 row_mask:0xf bank_mask:0xf
  s_nop 0
  v_add_f32_dpp v28, v28, v28 row_ror:4 row_mask:0xf bank_mask:0xf
  v_add_f32_dpp v29, v29, v29 row_ror:4 row_mask:0xf bank_mask:0xf
  s_nop 0
  v_add_f32_dpp v28, v28, v28 row_ror:8 row_mask:0xf bank_mask:0xf
  v_add_f32_dpp v29, v29, v29 row_ror:8 row_mask:0xf bank_mask:0xf
  s_nop 0
  v_cmp_eq_u32 vcc, 2, v3
  s_nop 1
  v_cndmask_b32 v32, v32, v28, vcc
  v_cndmask_b32 v33, v33, v29, vcc
  v_lshlrev_b32 v30, 16, v140
  v_and_b32 v31, 0xffff0000, v140
  v_mul_f32 v28, v30, v144
  v_mul_f32 v29, v30, v152
  v_fmac_f32 v28, v31, v145
  v_fmac_f32 v29, v31, v153
  v_lshlrev_b32 v30, 16, v141
  v_and_b32 v31, 0xffff0000, v141
  v_fmac_f32 v28, v30, v146
  v_fmac_f32 v29, v30, v154
  v_fmac_f32 v28, v31, v147
  v_fmac_f32 v29, v31, v155
  v_lshlrev_b32 v30, 16, v142
  v_and_b32 v31, 0xffff0000, v142
  v_fmac_f32 v28, v30, v148
  v_fmac_f32 v29, v30, v156
  v_fmac_f32 v28, v31, v149
  v_fmac_f32 v29, v31, v157
  v_lshlrev_b32 v30, 16, v143
  v_and_b32 v31, 0xffff0000, v143
  v_fmac_f32 v28, v30, v150
  v_fmac_f32 v29, v30, v158
  v_fmac_f32 v28, v31, v151
  v_fmac_f32 v29, v31, v159
  s_nop 1
  v_add_f32_dpp v28, v28, v28 row_ror:1 row_mask:0xf bank_mask:0xf
  v_add_f32_dpp v29, v29, v29 row_ror:1 row_mask:0xf bank_mask:0xf
  s_nop 0
  v_add_f32_dpp v28, v28, v28 row_ror:2 row_mask:0xf bank_mask:0xf
  v_add_f32_dpp v29, v29, v29 row_ror:2 row_mask:0xf bank_mask:0xf
  s_nop 0
  v_add_f32_dpp v28, v28, v28 row_ror:4 row_mask:0xf bank_mask:0xf
  v_add_f32_dpp v29, v29, v29 row_ror:4 row_mask:0xf bank_mask:0xf
  s_nop 0
  v_add_f32_dpp v28, v28, v28 row_ror:8 row_mask:0xf bank_mask:0xf
  v_add_f32_dpp v29, v29, v29 row_ror:8 row_mask:0xf bank_mask:0xf
  s_nop 0
  v_cmp_eq_u32 vcc, 3, v3
  s_nop 1
  v_cndmask_b32 v32, v32, v28, vcc
  v_cndmask_b32 v33, v33, v29, vcc
  v_cvt_pk_bf16_f32 v32, v32, v32
  v_cvt_pk_bf16_f32 v33, v33, v33
  v_mov_b32 v34, v32
  v_mov_b32 v35, v33
  s_nop 1
  v_permlane16_swap_b32 v32, v34
  v_permlane16_swap_b32 v33, v35
  v_and_b32 v32, 0xffff, v32
  v_and_b32 v33, 0xffff, v33
  v_lshl_or_b32 v32, v34, 16, v32
  v_lshl_or_b32 v33, v35, 16, v33
  s_lshl_b32 s28, s78, 7
  s_lshl_b32 s29, s64, 4
  s_add_u32 s28, s28, s29
  s_lshl_b32 s28, s28, 1
  s_lshl_b32 s29, s77, 10
  s_add_u32 s28, s28, s29
  s_add_u32 s28, s28, 65536
  s_add_u32 s29, s28, 32768
  v_lshrrev_b32 v7, 4, v1
  v_and_b32 v6, 15, v1
  v_lshlrev_b32 v6, 3, v6
  v_lshl_add_u32 v6, v7, 1, v6
  v_and_b32 v7, 1, v7
  v_lshlrev_b32 v7, 2, v7
  v_and_b32 v8, 15, v1
  v_add_u32 v7, v7, v8
  v_cmp_gt_u32 vcc, 4, v7
  s_and_saveexec_b64 s[72:73], vcc
  buffer_store_dword v32, v6, s[4:7], s28 offen sc1
  buffer_store_dword v33, v6, s[4:7], s29 offen sc1
  s_mov_b64 exec, s[72:73]
  s_lshr_b32 s79, s65, 6
  s_lshr_b32 s80, s65, 3
  s_and_b32 s80, s80, 7
  s_and_b32 s81, s65, 7
  s_mov_b32 s8, s38
  s_and_b32 s9, s39, 0xffff
  s_mov_b32 s10, 33554432
  s_mov_b32 s11, 0x00020000
  s_mov_b32 s12, s40
  s_and_b32 s13, s41, 0xffff
  s_mov_b32 s14, 33554432
  s_mov_b32 s15, 0x00020000
  s_lshl_b32 s30, s79, 24
  s_lshl_b32 s28, s80, 21
  s_add_u32 s30, s30, s28
  s_lshl_b32 s28, s81, 16
  s_add_u32 s30, s30, s28
  s_add_u32 s30, s30, 1572864
  s_lshl_b32 s31, s64, 13
  s_add_u32 s30, s30, s31
  v_lshrrev_b32 v2, 4, v1
  v_and_b32 v3, 15, v1
  v_add_u32 v24, 0, v2
  v_and_b32 v24, 15, v24
  v_xor_b32 v24, v24, v3
  v_lshlrev_b32 v24, 4, v24
  v_lshl_add_u32 v24, v2, 8, v24
  v_add_u32 v25, 4, v2
  v_and_b32 v25, 15, v25
  v_xor_b32 v25, v25, v3
  v_lshlrev_b32 v25, 4, v25
  v_lshl_add_u32 v25, v2, 8, v25
  v_add_u32 v26, 8, v2
  v_and_b32 v26, 15, v26
  v_xor_b32 v26, v26, v3
  v_lshlrev_b32 v26, 4, v26
  v_lshl_add_u32 v26, v2, 8, v26
  v_add_u32 v27, 12, v2
  v_and_b32 v27, 15, v27
  v_xor_b32 v27, v27, v3
  v_lshlrev_b32 v27, 4, v27
  v_lshl_add_u32 v27, v2, 8, v27
  s_add_u32 s75, s31, 32768
  s_mov_b32 m0, s75
  s_add_u32 s76, s30, 0
  buffer_load_dwordx4 v24, s[8:11], s76 offen offset:0 nt lds
  s_waitcnt vmcnt(1)
  buffer_load_dwordx4 v25, s[8:11], s76 offen offset:1024 nt lds
  s_waitcnt vmcnt(1)
  buffer_load_dwordx4 v26, s[8:11], s76 offen offset:2048 nt lds
  s_waitcnt vmcnt(1)
  buffer_load_dwordx4 v27, s[8:11], s76 offen offset:3072 nt lds
  s_waitcnt vmcnt(1)
  s_add_u32 s75, s31, 36864
  s_mov_b32 m0, s75
  s_add_u32 s76, s30, 4096
  buffer_load_dwordx4 v24, s[8:11], s76 offen offset:0 nt lds
  s_waitcnt vmcnt(1)
  buffer_load_dwordx4 v25, s[8:11], s76 offen offset:1024 nt lds
  s_waitcnt vmcnt(1)
  buffer_load_dwordx4 v26, s[8:11], s76 offen offset:2048 nt lds
  s_waitcnt vmcnt(1)
  buffer_load_dwordx4 v27, s[8:11], s76 offen offset:3072 nt lds
  s_waitcnt vmcnt(1)
  s_add_u32 s75, s31, 98304
  s_mov_b32 m0, s75
  s_add_u32 s76, s30, 0
  buffer_load_dwordx4 v24, s[12:15], s76 offen offset:0 nt lds
  s_waitcnt vmcnt(1)
  buffer_load_dwordx4 v25, s[12:15], s76 offen offset:1024 nt lds
  s_waitcnt vmcnt(1)
  buffer_load_dwordx4 v26, s[12:15], s76 offen offset:2048 nt lds
  s_waitcnt vmcnt(1)
  buffer_load_dwordx4 v27, s[12:15], s76 offen offset:3072 nt lds
  s_waitcnt vmcnt(1)
  s_add_u32 s75, s31, 102400
  s_mov_b32 m0, s75
  s_add_u32 s76, s30, 4096
  buffer_load_dwordx4 v24, s[12:15], s76 offen offset:0 nt lds
  s_waitcnt vmcnt(1)
  buffer_load_dwordx4 v25, s[12:15], s76 offen offset:1024 nt lds
  s_waitcnt vmcnt(1)
  buffer_load_dwordx4 v26, s[12:15], s76 offen offset:2048 nt lds
  s_waitcnt vmcnt(1)
  buffer_load_dwordx4 v27, s[12:15], s76 offen offset:3072 nt lds
  s_waitcnt vmcnt(1)
  s_mov_b32 s8, s44
  s_and_b32 s9, s45, 0xffff
  s_mov_b32 s10, 4194304
  s_mov_b32 s11, 0x00020000
  s_lshl_b32 s28, s65, 5
  s_lshl_b32 s29, s64, 2
  s_add_u32 s28, s28, s29
  s_lshl_b32 s28, s28, 10
  buffer_load_dwordx4 v[224:227], v240, s[8:11], s28 offen offset:0 nt
  buffer_load_dwordx4 v[228:231], v240, s[8:11], s28 offen offset:1024 nt
  buffer_load_dwordx4 v[232:235], v240, s[8:11], s28 offen offset:2048 nt
  buffer_load_dwordx4 v[236:239], v240, s[8:11], s28 offen offset:3072 nt
  v_and_b32 v4, 3, v3
  v_lshlrev_b32 v4, 8, v4
  v_lshl_add_u32 v4, v2, 4, v4
  s_lshl_b32 s35, s79, 13
  s_lshl_b32 s29, s80, 10
  s_add_u32 s35, s35, s29
  s_mov_b32 s74, 0x8000
L_s2a_tw_7:
  buffer_load_dwordx4 v[96:99], v4, s[4:7], s35 offen offset:0 sc1
  buffer_load_dwordx4 v[100:103], v4, s[4:7], s35 offen offset:64 sc1
  buffer_load_dwordx4 v[104:107], v4, s[4:7], s35 offen offset:128 sc1
  buffer_load_dwordx4 v[108:111], v4, s[4:7], s35 offen offset:192 sc1
  buffer_load_dword v244, v241, s[68:71], 0 offen sc1
  s_waitcnt vmcnt(0)
  v_max3_u32 v243, v96, v97, v98
  v_max3_u32 v243, v99, v100, v243
  v_max3_u32 v243, v101, v102, v243
  v_max3_u32 v243, v103, v104, v243
  v_max3_u32 v243, v105, v106, v243
  v_max3_u32 v243, v107, v108, v243
  v_max3_u32 v243, v109, v110, v243
  v_max_u32 v243, v111, v243
  v_and_b32 v244, 0x10101010, v244
  v_cmp_eq_u32 vcc, -1, v243
  s_mov_b64 s[98:99], vcc
  v_cmp_ne_u32 vcc, 0x10101010, v244
  s_or_b64 vcc, vcc, s[98:99]
  s_cmp_eq_u64 vcc, 0
  s_cbranch_scc1 L_s2a_twd_8
  s_sleep 8
  s_sub_u32 s74, s74, 1
  s_cmp_lg_u32 s74, 0
  s_cbranch_scc1 L_s2a_tw_7
L_s2a_twd_8:
  s_lshl_b32 s28, s64, 13
  s_add_u32 s28, s28, 32768
  v_add_u32 v8, 0, v2
  v_xor_b32 v8, v8, v3
  v_lshlrev_b32 v8, 4, v8
  v_lshl_add_u32 v8, v3, 8, v8
  v_add_u32 v8, s28, v8
  v_add_u32 v9, 4, v2
  v_xor_b32 v9, v9, v3
  v_lshlrev_b32 v9, 4, v9
  v_lshl_add_u32 v9, v3, 8, v9
  v_add_u32 v9, s28, v9
  v_add_u32 v10, 8, v2
  v_xor_b32 v10, v10, v3
  v_lshlrev_b32 v10, 4, v10
  v_lshl_add_u32 v10, v3, 8, v10
  v_add_u32 v10, s28, v10
  v_add_u32 v11, 12, v2
  v_xor_b32 v11, v11, v3
  v_lshlrev_b32 v11, 4, v11
  v_lshl_add_u32 v11, v3, 8, v11
  v_add_u32 v11, s28, v11
  ds_read_b128 v[64:67], v8 offset:0
  ds_read_b128 v[68:71], v9 offset:0
  ds_read_b128 v[72:75], v10 offset:0
  ds_read_b128 v[76:79], v11 offset:0
  ds_read_b128 v[80:83], v8 offset:4096
  ds_read_b128 v[84:87], v9 offset:4096
  ds_read_b128 v[88:91], v10 offset:4096
  ds_read_b128 v[92:95], v11 offset:4096
  v_cmp_gt_u32 vcc, 4, v3
  s_nop 1
  v_cndmask_b32 v96, 0, v96, vcc
  v_cndmask_b32 v97, 0, v97, vcc
  v_cndmask_b32 v98, 0, v98, vcc
  v_cndmask_b32 v99, 0, v99, vcc
  v_cndmask_b32 v100, 0, v100, vcc
  v_cndmask_b32 v101, 0, v101, vcc
  v_cndmask_b32 v102, 0, v102, vcc
  v_cndmask_b32 v103, 0, v103, vcc
  v_cndmask_b32 v104, 0, v104, vcc
  v_cndmask_b32 v105, 0, v105, vcc
  v_cndmask_b32 v106, 0, v106, vcc
  v_cndmask_b32 v107, 0, v107, vcc
  v_cndmask_b32 v108, 0, v108, vcc
  v_cndmask_b32 v109, 0, v109, vcc
  v_cndmask_b32 v110, 0, v110, vcc
  v_cndmask_b32 v111, 0, v111, vcc
  s_waitcnt lgkmcnt(0)
  v_mfma_f32_16x16x32_bf16 v[32:35], v[64:67], v[96:99], 0
  v_mfma_f32_16x16x32_bf16 v[32:35], v[68:71], v[100:103], v[32:35]
  v_mfma_f32_16x16x32_bf16 v[32:35], v[72:75], v[104:107], v[32:35]
  v_mfma_f32_16x16x32_bf16 v[32:35], v[76:79], v[108:111], v[32:35]
  v_mfma_f32_16x16x32_bf16 v[36:39], v[80:83], v[96:99], 0
  v_mfma_f32_16x16x32_bf16 v[36:39], v[84:87], v[100:103], v[36:39]
  v_mfma_f32_16x16x32_bf16 v[36:39], v[88:91], v[104:107], v[36:39]
  v_mfma_f32_16x16x32_bf16 v[36:39], v[92:95], v[108:111], v[36:39]
  v_lshrrev_b32 v4, 2, v3
  v_and_b32 v5, 3, v3
  v_lshl_add_u32 v6, v2, 2, v4
  v_lshrrev_b32 v7, 1, v5
  v_and_b32 v5, 1, v5
  v_lshlrev_b32 v5, 3, v5
  s_lshl_b32 s28, s64, 13
  s_add_u32 s28, s28, 98304
  v_add_u32 v12, 0, v7
  v_xor_b32 v12, v12, v6
  v_lshlrev_b32 v12, 4, v12
  v_lshl_add_u32 v12, v6, 8, v12
  v_add3_u32 v12, v12, v5, s28
  v_add_u32 v13, 2, v7
  v_xor_b32 v13, v13, v6
  v_lshlrev_b32 v13, 4, v13
  v_lshl_add_u32 v13, v6, 8, v13
  v_add3_u32 v13, v13, v5, s28
  v_add_u32 v14, 4, v7
  v_xor_b32 v14, v14, v6
  v_lshlrev_b32 v14, 4, v14
  v_lshl_add_u32 v14, v6, 8, v14
  v_add3_u32 v14, v14, v5, s28
  v_add_u32 v15, 6, v7
  v_xor_b32 v15, v15, v6
  v_lshlrev_b32 v15, 4, v15
  v_lshl_add_u32 v15, v6, 8, v15
  v_add3_u32 v15, v15, v5, s28
  v_add_u32 v16, 8, v7
  v_xor_b32 v16, v16, v6
  v_lshlrev_b32 v16, 4, v16
  v_lshl_add_u32 v16, v6, 8, v16
  v_add3_u32 v16, v16, v5, s28
  v_add_u32 v17, 10, v7
  v_xor_b32 v17, v17, v6
  v_lshlrev_b32 v17, 4, v17
  v_lshl_add_u32 v17, v6, 8, v17
  v_add3_u32 v17, v17, v5, s28
  v_add_u32 v18, 12, v7
  v_xor_b32 v18, v18, v6
  v_lshlrev_b32 v18, 4, v18
  v_lshl_add_u32 v18, v6, 8, v18
  v_add3_u32 v18, v18, v5, s28
  v_add_u32 v19, 14, v7
  v_xor_b32 v19, v19, v6
  v_lshlrev_b32 v19, 4, v19
  v_lshl_add_u32 v19, v6, 8, v19
  v_add3_u32 v19, v19, v5, s28
  v_cvt_pk_bf16_f32 v44, v32, v33
  v_cvt_pk_bf16_f32 v45, v34, v35
  v_cvt_pk_bf16_f32 v46, v36, v37
  v_cvt_pk_bf16_f32 v47, v38, v39
  v_lshlrev_b32 v32, 16, v44
  v_and_b32 v33, 0xffff0000, v44
  v_lshlrev_b32 v34, 16, v45
  v_and_b32 v35, 0xffff0000, v45
  v_lshlrev_b32 v36, 16, v46
  v_and_b32 v37, 0xffff0000, v46
  v_lshlrev_b32 v38, 16, v47
  v_and_b32 v39, 0xffff0000, v47
  v_mul_f32 v32, 0x3db504f3, v32
  v_mul_f32 v33, 0x3db504f3, v33
  v_mul_f32 v34, 0x3db504f3, v34
  v_mul_f32 v35, 0x3db504f3, v35
  v_mul_f32 v36, 0x3db504f3, v36
  v_mul_f32 v37, 0x3db504f3, v37
  v_mul_f32 v38, 0x3db504f3, v38
  v_mul_f32 v39, 0x3db504f3, v39
  v_cvt_pk_bf16_f32 v44, v32, v33
  v_cvt_pk_bf16_f32 v45, v34, v35
  v_cvt_pk_bf16_f32 v46, v36, v37
  v_cvt_pk_bf16_f32 v47, v38, v39
  v_lshlrev_b32 v32, 16, v44
  v_and_b32 v33, 0xffff0000, v44
  v_lshlrev_b32 v34, 16, v45
  v_and_b32 v35, 0xffff0000, v45
  v_lshlrev_b32 v36, 16, v46
  v_and_b32 v37, 0xffff0000, v46
  v_lshlrev_b32 v38, 16, v47
  v_and_b32 v39, 0xffff0000, v47
  v_max3_f32 v40, v32, v33, v34
  v_max3_f32 v41, v35, v36, v37
  v_max3_f32 v40, v38, v39, v40
  v_max_f32 v40, v40, v41
  v_mov_b32 v41, v40
  s_nop 1
  v_permlane16_swap_b32 v40, v41
  v_max_f32 v40, v40, v41
  v_mov_b32 v41, v40
  s_nop 1
  v_permlane32_swap_b32 v40, v41
  v_max_f32 v40, v40, v41
  s_lshl_b32 s28, s64, 6
  v_lshlrev_b32 v4, 2, v3
  v_add_u32 v5, s28, v4
  v_cmp_gt_u32 vcc, 16, v1
  s_and_saveexec_b64 s[72:73], vcc
  ds_write_b32 v5, v40 offset:4096
  s_mov_b64 exec, s[72:73]
  s_waitcnt lgkmcnt(0)
  s_barrier
  ds_read_b32 v48, v4 offset:4096
  ds_read_b32 v49, v4 offset:4160
  ds_read_b32 v50, v4 offset:4224
  ds_read_b32 v51, v4 offset:4288
  ds_read_b32 v52, v4 offset:4352
  ds_read_b32 v53, v4 offset:4416
  ds_read_b32 v54, v4 offset:4480
  ds_read_b32 v55, v4 offset:4544
  s_waitcnt lgkmcnt(0)
  v_max3_f32 v40, v48, v49, v50
  v_max3_f32 v41, v51, v52, v53
  v_max3_f32 v40, v54, v55, v40
  v_max_f32 v40, v40, v41
  v_sub_f32 v32, v32, v40
  v_sub_f32 v33, v33, v40
  v_sub_f32 v34, v34, v40
  v_sub_f32 v35, v35, v40
  v_sub_f32 v36, v36, v40
  v_sub_f32 v37, v37, v40
  v_sub_f32 v38, v38, v40
  v_sub_f32 v39, v39, v40
  v_mul_f32 v32, 0x3fb8aa3b, v32
  v_mul_f32 v33, 0x3fb8aa3b, v33
  v_mul_f32 v34, 0x3fb8aa3b, v34
  v_mul_f32 v35, 0x3fb8aa3b, v35
  v_mul_f32 v36, 0x3fb8aa3b, v36
  v_mul_f32 v37, 0x3fb8aa3b, v37
  v_mul_f32 v38, 0x3fb8aa3b, v38
  v_mul_f32 v39, 0x3fb8aa3b, v39
  v_exp_f32 v32, v32
  v_exp_f32 v33, v33
  v_exp_f32 v34, v34
  v_exp_f32 v35, v35
  v_exp_f32 v36, v36
  v_exp_f32 v37, v37
  v_exp_f32 v38, v38
  v_exp_f32 v39, v39
  s_nop 0
  v_add_f32 v41, v32, v33
  v_add_f32 v42, v34, v35
  v_add_f32 v43, v36, v37
  v_add_f32 v44, v38, v39
  v_add_f32 v41, v41, v42
  v_add_f32 v43, v43, v44
  v_add_f32 v41, v41, v43
  v_mov_b32 v42, v41
  s_nop 1
  v_permlane16_swap_b32 v41, v42
  v_add_f32 v41, v41, v42
  v_mov_b32 v42, v41
  s_nop 1
  v_permlane32_swap_b32 v41, v42
  v_add_f32 v41, v41, v42
  v_cvt_pk_bf16_f32 v44, v32, v33
  v_cvt_pk_bf16_f32 v45, v34, v35
  v_cvt_pk_bf16_f32 v46, v36, v37
  v_cvt_pk_bf16_f32 v47, v38, v39
  ds_read_b64_tr_b16 v[112:113], v12
  ds_read_b64_tr_b16 v[114:115], v12 offset:4096
  ds_read_b64_tr_b16 v[116:117], v13
  ds_read_b64_tr_b16 v[118:119], v13 offset:4096
  ds_read_b64_tr_b16 v[120:121], v14
  ds_read_b64_tr_b16 v[122:123], v14 offset:4096
  ds_read_b64_tr_b16 v[124:125], v15
  ds_read_b64_tr_b16 v[126:127], v15 offset:4096
  s_waitcnt lgkmcnt(6)
  v_mfma_f32_16x16x32_bf16 v[128:131], v[112:115], v[44:47], 0
  ds_read_b64_tr_b16 v[112:113], v16
  ds_read_b64_tr_b16 v[114:115], v16 offset:4096
  s_waitcnt lgkmcnt(6)
  v_mfma_f32_16x16x32_bf16 v[132:135], v[116:119], v[44:47], 0
  ds_read_b64_tr_b16 v[116:117], v17
  ds_read_b64_tr_b16 v[118:119], v17 offset:4096
  s_waitcnt lgkmcnt(6)
  v_mfma_f32_16x16x32_bf16 v[136:139], v[120:123], v[44:47], 0
  ds_read_b64_tr_b16 v[120:121], v18
  ds_read_b64_tr_b16 v[122:123], v18 offset:4096
  s_waitcnt lgkmcnt(6)
  v_mfma_f32_16x16x32_bf16 v[140:143], v[124:127], v[44:47], 0
  ds_read_b64_tr_b16 v[124:125], v19
  ds_read_b64_tr_b16 v[126:127], v19 offset:4096
  s_waitcnt lgkmcnt(6)
  v_mfma_f32_16x16x32_bf16 v[144:147], v[112:115], v[44:47], 0
  s_waitcnt lgkmcnt(4)
  v_mfma_f32_16x16x32_bf16 v[148:151], v[116:119], v[44:47], 0
  s_waitcnt lgkmcnt(2)
  v_mfma_f32_16x16x32_bf16 v[152:155], v[120:123], v[44:47], 0
  s_waitcnt lgkmcnt(0)
  v_mfma_f32_16x16x32_bf16 v[156:159], v[124:127], v[44:47], 0
  s_lshl_b32 s28, s64, 11
  v_lshlrev_b32 v5, 9, v3
  v_lshl_add_u32 v5, v2, 4, v5
  v_add_u32 v5, s28, v5
  s_lshl_b32 s28, s64, 6
  v_add_u32 v6, s28, v4
  v_cmp_gt_u32 vcc, 4, v3
  s_nop 7
  s_and_saveexec_b64 s[72:73], vcc
  ds_write_b128 v5, v[128:131] offset:8192
  ds_write_b128 v5, v[132:135] offset:8256
  ds_write_b128 v5, v[136:139] offset:8320
  ds_write_b128 v5, v[140:143] offset:8384
  ds_write_b128 v5, v[144:147] offset:8448
  ds_write_b128 v5, v[148:151] offset:8512
  ds_write_b128 v5, v[152:155] offset:8576
  ds_write_b128 v5, v[156:159] offset:8640
  s_mov_b64 exec, s[72:73]
  v_cmp_gt_u32 vcc, 16, v1
  s_and_saveexec_b64 s[72:73], vcc
  ds_write_b32 v6, v41 offset:5120
  s_mov_b64 exec, s[72:73]
  s_waitcnt lgkmcnt(0)
  s_barrier
  v_lshlrev_b32 v5, 2, v0
  ds_read_b32 v48, v5 offset:8192
  ds_read_b32 v49, v5 offset:10240
  ds_read_b32 v50, v5 offset:12288
  ds_read_b32 v51, v5 offset:14336
  ds_read_b32 v52, v5 offset:16384
  ds_read_b32 v53, v5 offset:18432
  ds_read_b32 v54, v5 offset:20480
  ds_read_b32 v55, v5 offset:22528
  s_waitcnt lgkmcnt(0)
  v_add_f32 v48, v48, v49
  v_add_f32 v50, v50, v51
  v_add_f32 v52, v52, v53
  v_add_f32 v54, v54, v55
  v_add_f32 v48, v48, v50
  v_add_f32 v52, v52, v54
  v_add_f32 v48, v48, v52
  s_lshl_b32 s28, s65, 11
  s_add_u32 s28, s28, 262144
  buffer_store_dword v48, v5, s[4:7], s28 offen sc1
  s_cmp_lg_u32 s64, 0
  s_cbranch_scc1 L_s2a_st_9
  ds_read_b32 v56, v4 offset:5120
  ds_read_b32 v57, v4 offset:5184
  ds_read_b32 v58, v4 offset:5248
  ds_read_b32 v59, v4 offset:5312
  ds_read_b32 v60, v4 offset:5376
  ds_read_b32 v61, v4 offset:5440
  ds_read_b32 v62, v4 offset:5504
  ds_read_b32 v63, v4 offset:5568
  s_waitcnt lgkmcnt(0)
  v_add_f32 v56, v56, v57
  v_add_f32 v58, v58, v59
  v_add_f32 v60, v60, v61
  v_add_f32 v62, v62, v63
  v_add_f32 v56, v56, v58
  v_add_f32 v60, v60, v62
  v_add_f32 v56, v56, v60
  v_mov_b32 v41, v56
  s_lshl_b32 s28, s65, 5
  s_add_u32 s28, s28, 524288
  v_lshlrev_b32 v6, 3, v3
  v_cmp_gt_u32 vcc, 4, v1
  s_and_saveexec_b64 s[72:73], vcc
  buffer_store_dwordx2 v[40:41], v6, s[4:7], s28 offen sc1
  s_mov_b64 exec, s[72:73]
L_s2a_st_9:
  s_barrier
  s_lshr_b32 s80, s65, 4
  v_lshrrev_b32 v2, 5, v1
  v_and_b32 v3, 31, v1
  v_lshlrev_b32 v4, 17, v2
  v_lshl_add_u32 v4, v3, 2, v4
  v_lshlrev_b32 v5, 11, v2
  s_lshl_b32 s35, s80, 14
  s_lshr_b32 s29, s65, 2
  s_and_b32 s29, s29, 3
  s_lshl_b32 s75, s29, 9
  s_add_u32 s35, s35, s75
  s_and_b32 s75, s65, 3
  s_lshl_b32 s75, s75, 7
  s_add_u32 s35, s35, s75
  s_add_u32 s35, s35, 262144
  s_lshl_b32 s76, s80, 8
  s_lshl_b32 s75, s29, 3
  s_add_u32 s76, s76, s75
  s_add_u32 s76, s76, 524288
  s_mov_b32 s74, 0x8000
L_s3a_tw_10:
  buffer_load_dwordx2 v[72:73], v5, s[4:7], s76 offen offset:0 sc1
  buffer_load_dwordx2 v[74:75], v5, s[4:7], s76 offen offset:32 sc1
  buffer_load_dwordx2 v[76:77], v5, s[4:7], s76 offen offset:64 sc1
  buffer_load_dwordx2 v[78:79], v5, s[4:7], s76 offen offset:96 sc1
  buffer_load_dwordx2 v[80:81], v5, s[4:7], s76 offen offset:128 sc1
  buffer_load_dwordx2 v[82:83], v5, s[4:7], s76 offen offset:160 sc1
  buffer_load_dwordx2 v[84:85], v5, s[4:7], s76 offen offset:192 sc1
  buffer_load_dwordx2 v[86:87], v5, s[4:7], s76 offen offset:224 sc1
  s_mov_b32 s28, s35
  buffer_load_dword v64, v4, s[4:7], s28 offen sc1
  s_add_u32 s28, s28, 2048
  buffer_load_dword v65, v4, s[4:7], s28 offen sc1
  s_add_u32 s28, s28, 2048
  buffer_load_dword v66, v4, s[4:7], s28 offen sc1
  s_add_u32 s28, s28, 2048
  buffer_load_dword v67, v4, s[4:7], s28 offen sc1
  s_add_u32 s28, s28, 2048
  buffer_load_dword v68, v4, s[4:7], s28 offen sc1
  s_add_u32 s28, s28, 2048
  buffer_load_dword v69, v4, s[4:7], s28 offen sc1
  s_add_u32 s28, s28, 2048
  buffer_load_dword v70, v4, s[4:7], s28 offen sc1
  s_add_u32 s28, s28, 2048
  buffer_load_dword v71, v4, s[4:7], s28 offen sc1
  buffer_load_dword v244, v241, s[68:71], 0 offen sc1
  s_waitcnt vmcnt(0)
  v_max3_u32 v243, v64, v65, v66
  v_max3_u32 v243, v67, v68, v243
  v_max3_u32 v243, v69, v70, v243
  v_max3_u32 v243, v71, v72, v243
  v_max3_u32 v243, v73, v74, v243
  v_max3_u32 v243, v75, v76, v243
  v_max3_u32 v243, v77, v78, v243
  v_max3_u32 v243, v79, v80, v243
  v_max3_u32 v243, v81, v82, v243
  v_max3_u32 v243, v83, v84, v243
  v_max3_u32 v243, v85, v86, v243
  v_max_u32 v243, v87, v243
  v_and_b32 v244, 0x10101010, v244
  v_cmp_eq_u32 vcc, -1, v243
  s_mov_b64 s[98:99], vcc
  v_cmp_ne_u32 vcc, 0x10101010, v244
  s_or_b64 vcc, vcc, s[98:99]
  s_cmp_eq_u64 vcc, 0
  s_cbranch_scc1 L_s3a_twd_11
  s_sleep 8
  s_sub_u32 s74, s74, 1
  s_cmp_lg_u32 s74, 0
  s_cbranch_scc1 L_s3a_tw_10
L_s3a_twd_11:
  v_max3_f32 v24, v72, v74, v76
  v_max3_f32 v24, v78, v80, v24
  v_max3_f32 v24, v82, v84, v24
  v_max_f32 v24, v86, v24
  v_sub_f32 v72, v72, v24
  v_sub_f32 v74, v74, v24
  v_sub_f32 v76, v76, v24
  v_sub_f32 v78, v78, v24
  v_sub_f32 v80, v80, v24
  v_sub_f32 v82, v82, v24
  v_sub_f32 v84, v84, v24
  v_sub_f32 v86, v86, v24
  v_mul_f32 v72, 0x3fb8aa3b, v72
  v_mul_f32 v74, 0x3fb8aa3b, v74
  v_mul_f32 v76, 0x3fb8aa3b, v76
  v_mul_f32 v78, 0x3fb8aa3b, v78
  v_mul_f32 v80, 0x3fb8aa3b, v80
  v_mul_f32 v82, 0x3fb8aa3b, v82
  v_mul_f32 v84, 0x3fb8aa3b, v84
  v_mul_f32 v86, 0x3fb8aa3b, v86
  v_exp_f32 v72, v72
  v_exp_f32 v74, v74
  v_exp_f32 v76, v76
  v_exp_f32 v78, v78
  v_exp_f32 v80, v80
  v_exp_f32 v82, v82
  v_exp_f32 v84, v84
  v_exp_f32 v86, v86
  s_nop 0
  v_mul_f32 v25, v72, v73
  v_fmac_f32 v25, v74, v75
  v_fmac_f32 v25, v76, v77
  v_fmac_f32 v25, v78, v79
  v_fmac_f32 v25, v80, v81
  v_fmac_f32 v25, v82, v83
  v_fmac_f32 v25, v84, v85
  v_fmac_f32 v25, v86, v87
  v_mul_f32 v26, v72, v64
  v_fmac_f32 v26, v74, v65
  v_fmac_f32 v26, v76, v66
  v_fmac_f32 v26, v78, v67
  v_fmac_f32 v26, v80, v68
  v_fmac_f32 v26, v82, v69
  v_fmac_f32 v26, v84, v70
  v_fmac_f32 v26, v86, v71
  v_rcp_f32 v25, v25
  s_nop 0
  v_mul_f32 v26, v26, v25
  v_cvt_pk_bf16_f32 v26, v26, v26
  v_lshlrev_b32 v26, 16, v26
  s_lshl_b32 s28, s64, 2
  s_add_u32 s29, s28, 0
  v_readlane_b32 s80, v26, s29
  s_add_u32 s29, s28, 1
  v_readlane_b32 s81, v26, s29
  s_add_u32 s29, s28, 2
  v_readlane_b32 s82, v26, s29
  s_add_u32 s29, s28, 3
  v_readlane_b32 s83, v26, s29
  s_add_u32 s29, s28, 32
  v_readlane_b32 s84, v26, s29
  s_add_u32 s29, s28, 33
  v_readlane_b32 s85, v26, s29
  s_add_u32 s29, s28, 34
  v_readlane_b32 s86, v26, s29
  s_add_u32 s29, s28, 35
  v_readlane_b32 s87, v26, s29
  s_nop 1
  v_mov_b32 v32, 0
  v_mov_b32 v33, 0
  v_mov_b32 v34, 0
  v_mov_b32 v35, 0
  v_mov_b32 v36, 0
  v_mov_b32 v37, 0
  v_mov_b32 v38, 0
  v_mov_b32 v39, 0
  v_mov_b32 v40, 0
  v_mov_b32 v41, 0
  v_mov_b32 v42, 0
  v_mov_b32 v43, 0
  v_mov_b32 v44, 0
  v_mov_b32 v45, 0
  v_mov_b32 v46, 0
  v_mov_b32 v47, 0
  v_lshlrev_b32 v30, 16, v224
  v_and_b32 v31, 0xffff0000, v224
  v_fmac_f32 v32, s80, v30
  v_fmac_f32 v33, s80, v31
  v_fmac_f32 v40, s84, v30
  v_fmac_f32 v41, s84, v31
  v_lshlrev_b32 v30, 16, v225
  v_and_b32 v31, 0xffff0000, v225
  v_fmac_f32 v34, s80, v30
  v_fmac_f32 v35, s80, v31
  v_fmac_f32 v42, s84, v30
  v_fmac_f32 v43, s84, v31
  v_lshlrev_b32 v30, 16, v226
  v_and_b32 v31, 0xffff0000, v226
  v_fmac_f32 v36, s80, v30
  v_fmac_f32 v37, s80, v31
  v_fmac_f32 v44, s84, v30
  v_fmac_f32 v45, s84, v31
  v_lshlrev_b32 v30, 16, v227
  v_and_b32 v31, 0xffff0000, v227
  v_fmac_f32 v38, s80, v30
  v_fmac_f32 v39, s80, v31
  v_fmac_f32 v46, s84, v30
  v_fmac_f32 v47, s84, v31
  v_lshlrev_b32 v30, 16, v228
  v_and_b32 v31, 0xffff0000, v228
  v_fmac_f32 v32, s81, v30
  v_fmac_f32 v33, s81, v31
  v_fmac_f32 v40, s85, v30
  v_fmac_f32 v41, s85, v31
  v_lshlrev_b32 v30, 16, v229
  v_and_b32 v31, 0xffff0000, v229
  v_fmac_f32 v34, s81, v30
  v_fmac_f32 v35, s81, v31
  v_fmac_f32 v42, s85, v30
  v_fmac_f32 v43, s85, v31
  v_lshlrev_b32 v30, 16, v230
  v_and_b32 v31, 0xffff0000, v230
  v_fmac_f32 v36, s81, v30
  v_fmac_f32 v37, s81, v31
  v_fmac_f32 v44, s85, v30
  v_fmac_f32 v45, s85, v31
  v_lshlrev_b32 v30, 16, v231
  v_and_b32 v31, 0xffff0000, v231
  v_fmac_f32 v38, s81, v30
  v_fmac_f32 v39, s81, v31
  v_fmac_f32 v46, s85, v30
  v_fmac_f32 v47, s85, v31
  v_lshlrev_b32 v30, 16, v232
  v_and_b32 v31, 0xffff0000, v232
  v_fmac_f32 v32, s82, v30
  v_fmac_f32 v33, s82, v31
  v_fmac_f32 v40, s86, v30
  v_fmac_f32 v41, s86, v31
  v_lshlrev_b32 v30, 16, v233
  v_and_b32 v31, 0xffff0000, v233
  v_fmac_f32 v34, s82, v30
  v_fmac_f32 v35, s82, v31
  v_fmac_f32 v42, s86, v30
  v_fmac_f32 v43, s86, v31
  v_lshlrev_b32 v30, 16, v234
  v_and_b32 v31, 0xffff0000, v234
  v_fmac_f32 v36, s82, v30
  v_fmac_f32 v37, s82, v31
  v_fmac_f32 v44, s86, v30
  v_fmac_f32 v45, s86, v31
  v_lshlrev_b32 v30, 16, v235
  v_and_b32 v31, 0xffff0000, v235
  v_fmac_f32 v38, s82, v30
  v_fmac_f32 v39, s82, v31
  v_fmac_f32 v46, s86, v30
  v_fmac_f32 v47, s86, v31
  v_lshlrev_b32 v30, 16, v236
  v_and_b32 v31, 0xffff0000, v236
  v_fmac_f32 v32, s83, v30
  v_fmac_f32 v33, s83, v31
  v_fmac_f32 v40, s87, v30
  v_fmac_f32 v41, s87, v31
  v_lshlrev_b32 v30, 16, v237
  v_and_b32 v31, 0xffff0000, v237
  v_fmac_f32 v34, s83, v30
  v_fmac_f32 v35, s83, v31
  v_fmac_f32 v42, s87, v30
  v_fmac_f32 v43, s87, v31
  v_lshlrev_b32 v30, 16, v238
  v_and_b32 v31, 0xffff0000, v238
  v_fmac_f32 v36, s83, v30
  v_fmac_f32 v37, s83, v31
  v_fmac_f32 v44, s87, v30
  v_fmac_f32 v45, s87, v31
  v_lshlrev_b32 v30, 16, v239
  v_and_b32 v31, 0xffff0000, v239
  v_fmac_f32 v38, s83, v30
  v_fmac_f32 v39, s83, v31
  v_fmac_f32 v46, s87, v30
  v_fmac_f32 v47, s87, v31
  s_lshl_b32 s28, s64, 12
  v_lshlrev_b32 v6, 5, v1
  v_add_u32 v6, s28, v6
  ds_write_b128 v6, v[32:35] offset:0
  ds_write_b128 v6, v[36:39] offset:16
  ds_write_b128 v6, v[40:43] offset:2048
  ds_write_b128 v6, v[44:47] offset:2064
  s_waitcnt lgkmcnt(0)
  s_barrier
  v_lshlrev_b32 v6, 3, v0
  ds_read_b64 v[48:49], v6 offset:0
  ds_read_b64 v[50:51], v6 offset:4096
  ds_read_b64 v[52:53], v6 offset:8192
  ds_read_b64 v[54:55], v6 offset:12288
  ds_read_b64 v[56:57], v6 offset:16384
  ds_read_b64 v[58:59], v6 offset:20480
  ds_read_b64 v[60:61], v6 offset:24576
  ds_read_b64 v[62:63], v6 offset:28672
  v_lshrrev_b32 v7, 8, v0
  v_lshlrev_b32 v7, 18, v7
  v_bfe_u32 v8, v0, 4, 4
  v_lshl_add_u32 v7, v8, 14, v7
  v_and_b32 v8, 15, v0
  v_lshl_add_u32 v7, v8, 3, v7
  s_lshl_b32 s34, s65, 7
  s_add_u32 s34, s34, 1048576
  s_waitcnt lgkmcnt(0)
  v_add_f32 v48, v48, v50
  v_add_f32 v52, v52, v54
  v_add_f32 v56, v56, v58
  v_add_f32 v60, v60, v62
  v_add_f32 v48, v48, v52
  v_add_f32 v56, v56, v60
  v_add_f32 v48, v48, v56
  v_add_f32 v49, v49, v51
  v_add_f32 v53, v53, v55
  v_add_f32 v57, v57, v59
  v_add_f32 v61, v61, v63
  v_add_f32 v49, v49, v53
  v_add_f32 v57, v57, v61
  v_add_f32 v49, v49, v57
  buffer_store_dwordx2 v[48:49], v7, s[4:7], s34 offen sc1
  s_cmp_ge_u32 s65, 64
  s_cbranch_scc1 L_END
  s_lshl_b32 s35, s65, 14
  s_lshl_b32 s29, s64, 11
  s_add_u32 s35, s35, s29
  s_add_u32 s35, s35, 1048576
  s_barrier
  s_mov_b32 s74, 0x8000
L_s4_tw_12:
  buffer_load_dwordx4 v[32:35], v240, s[4:7], s35 offen sc1
  buffer_load_dwordx4 v[36:39], v240, s[4:7], s35 offen offset:1024 sc1
  buffer_load_dword v244, v241, s[68:71], 0 offen sc1
  s_waitcnt vmcnt(0)
  v_max3_u32 v243, v32, v33, v34
  v_max3_u32 v243, v35, v36, v243
  v_max3_u32 v243, v37, v38, v243
  v_max_u32 v243, v39, v243
  v_and_b32 v244, 0x10101010, v244
  v_cmp_eq_u32 vcc, -1, v243
  s_mov_b64 s[98:99], vcc
  v_cmp_ne_u32 vcc, 0x10101010, v244
  s_or_b64 vcc, vcc, s[98:99]
  s_cmp_eq_u64 vcc, 0
  s_cbranch_scc1 L_s4_twd_13
  s_sleep 8
  s_sub_u32 s74, s74, 1
  s_cmp_lg_u32 s74, 0
  s_cbranch_scc1 L_s4_tw_12
L_s4_twd_13:
  v_add_f32 v32, v32, v36
  v_add_f32 v33, v33, v37
  v_add_f32 v34, v34, v38
  v_add_f32 v35, v35, v39
  s_nop 1
  v_add_f32_dpp v32, v32, v32 row_ror:8 row_mask:0xf bank_mask:0xf
  v_add_f32_dpp v33, v33, v33 row_ror:8 row_mask:0xf bank_mask:0xf
  v_add_f32_dpp v34, v34, v34 row_ror:8 row_mask:0xf bank_mask:0xf
  v_add_f32_dpp v35, v35, v35 row_ror:8 row_mask:0xf bank_mask:0xf
  v_mov_b32 v36, v32
  v_mov_b32 v37, v33
  v_mov_b32 v38, v34
  v_mov_b32 v39, v35
  v_permlane16_swap_b32 v32, v36
  v_permlane16_swap_b32 v33, v37
  v_permlane16_swap_b32 v34, v38
  v_permlane16_swap_b32 v35, v39
  v_add_f32 v32, v32, v36
  v_add_f32 v33, v33, v37
  v_add_f32 v34, v34, v38
  v_add_f32 v35, v35, v39
  v_mov_b32 v36, v32
  v_mov_b32 v37, v33
  v_mov_b32 v38, v34
  v_mov_b32 v39, v35
  v_permlane32_swap_b32 v32, v36
  v_permlane32_swap_b32 v33, v37
  v_permlane32_swap_b32 v34, v38
  v_permlane32_swap_b32 v35, v39
  v_add_f32 v32, v32, v36
  v_add_f32 v33, v33, v37
  v_add_f32 v34, v34, v38
  v_add_f32 v35, v35, v39
  s_lshl_b32 s28, s64, 7
  v_add_u32 v6, s28, v240
  v_cmp_gt_u32 vcc, 8, v1
  s_and_saveexec_b64 s[72:73], vcc
  ds_write_b128 v6, v[32:35] offset:0
  s_mov_b64 exec, s[72:73]
  s_waitcnt lgkmcnt(0)
  s_barrier
  s_cmp_lg_u32 s64, 0
  s_cbranch_scc1 L_END
  ds_read_b32 v48, v241 offset:0
  ds_read_b32 v49, v241 offset:128
  ds_read_b32 v50, v241 offset:256
  ds_read_b32 v51, v241 offset:384
  ds_read_b32 v52, v241 offset:512
  ds_read_b32 v53, v241 offset:640
  ds_read_b32 v54, v241 offset:768
  ds_read_b32 v55, v241 offset:896
  s_waitcnt lgkmcnt(0)
  v_add_f32 v48, v48, v49
  v_add_f32 v50, v50, v51
  v_add_f32 v52, v52, v53
  v_add_f32 v54, v54, v55
  v_add_f32 v48, v48, v50
  v_add_f32 v52, v52, v54
  v_add_f32 v48, v48, v52
  v_cvt_pk_bf16_f32 v48, v48, v48
  s_mov_b32 s8, s58
  s_and_b32 s9, s59, 0xffff
  s_mov_b32 s10, 4096
  s_mov_b32 s11, 0x00020000
  s_lshr_b32 s28, s65, 5
  s_lshl_b32 s28, s28, 10
  s_lshr_b32 s29, s65, 4
  s_and_b32 s29, s29, 1
  s_lshl_b32 s29, s29, 11
  s_add_u32 s28, s28, s29
  s_and_b32 s29, s65, 15
  s_lshl_b32 s29, s29, 6
  s_add_u32 s28, s28, s29
  v_lshlrev_b32 v6, 1, v1
  v_cmp_gt_u32 vcc, 32, v1
  s_and_saveexec_b64 s[72:73], vcc
  buffer_store_short v48, v6, s[8:11], s28 offen
  s_mov_b64 exec, s[72:73]
  s_branch L_END
L_BPATH:
  s_mov_b32 s65, s2
  s_and_b32 s77, s2, 7
  s_lshl_b32 s77, s77, 2
  s_lshr_b32 s28, s2, 3
  s_and_b32 s28, s28, 3
  s_add_u32 s77, s77, s28
  s_lshr_b32 s78, s2, 5
  v_lshrrev_b32 v7, 8, v0
  v_lshlrev_b32 v7, 18, v7
  v_bfe_u32 v8, v0, 4, 4
  v_lshl_add_u32 v7, v8, 14, v7
  v_and_b32 v8, 15, v0
  v_lshl_add_u32 v7, v8, 3, v7
  s_lshl_b32 s34, s65, 7
  s_add_u32 s34, s34, 1572864
  buffer_store_dwordx2 v[246:247], v7, s[4:7], s34 offen sc1
  s_lshl_b32 s28, s77, 2
  s_add_u32 s28, s28, s78
  s_lshl_b32 s28, s28, 10
  s_add_u32 s28, s28, 655360
  v_lshlrev_b32 v5, 2, v0
  v_cmp_gt_u32 vcc, 256, v0
  s_and_saveexec_b64 s[72:73], vcc
  buffer_store_dword v246, v5, s[4:7], s28 offen sc1
  s_mov_b64 exec, s[72:73]
  s_lshl_b32 s28, s2, 8
  s_add_u32 s28, s28, 589824
  v_lshlrev_b32 v5, 3, v0
  v_cmp_gt_u32 vcc, 32, v0
  s_and_saveexec_b64 s[72:73], vcc
  buffer_store_dwordx2 v[246:247], v5, s[4:7], s28 offen sc1
  s_mov_b64 exec, s[72:73]
  s_lshl_b32 s28, s2, 15
  s_lshl_b32 s29, s64, 12
  s_add_u32 s28, s28, s29
  s_add_u32 s28, s28, 4194304
  buffer_store_dwordx4 v[246:249], v240, s[4:7], s28 offen offset:0 sc1
  buffer_store_dwordx4 v[246:249], v240, s[4:7], s28 offen offset:1024 sc1
  buffer_store_dwordx4 v[246:249], v240, s[4:7], s28 offen offset:2048 sc1
  buffer_store_dwordx4 v[246:249], v240, s[4:7], s28 offen offset:3072 sc1
  s_mov_b32 s16, s48
  s_and_b32 s17, s49, 0xffff
  s_mov_b32 s18, 16777216
  s_mov_b32 s19, 0x00020000
  s_lshl_b32 s30, s2, 17
  s_lshl_b32 s31, s64, 14
  s_add_u32 s30, s30, s31
  s_add_u32 s31, s31, 32768
  v_xor_b32 v24, 0, v240
  s_add_u32 s75, s31, 0
  s_mov_b32 m0, s75
  s_add_u32 s76, s30, 0
  buffer_load_dwordx4 v24, s[16:19], s76 offen offset:0 nt lds
  v_xor_b32 v25, 16, v240
  buffer_load_dwordx4 v25, s[16:19], s76 offen offset:1024 nt lds
  s_waitcnt vmcnt(1)
  v_xor_b32 v26, 32, v240
  buffer_load_dwordx4 v26, s[16:19], s76 offen offset:2048 nt lds
  s_waitcnt vmcnt(1)
  v_xor_b32 v27, 48, v240
  buffer_load_dwordx4 v27, s[16:19], s76 offen offset:3072 nt lds
  s_waitcnt vmcnt(1)
  s_waitcnt vmcnt(4)
  s_barrier
  s_cmp_lg_u32 s64, 0
  s_cbranch_scc1 L_s1b_bit4_14
  v_mov_b32 v250, s2
  v_mov_b32 v251, 0x10
  v_cmp_gt_u32 vcc, 1, v1
  s_and_saveexec_b64 s[72:73], vcc
  buffer_store_byte v251, v250, s[68:71], 0 offen sc1
  s_mov_b64 exec, s[72:73]
L_s1b_bit4_14:
  v_xor_b32 v24, 64, v240
  s_add_u32 s75, s31, 4096
  s_mov_b32 m0, s75
  s_add_u32 s76, s30, 4096
  buffer_load_dwordx4 v24, s[16:19], s76 offen offset:0 nt lds
  s_waitcnt vmcnt(1)
  v_xor_b32 v25, 80, v240
  buffer_load_dwordx4 v25, s[16:19], s76 offen offset:1024 nt lds
  s_waitcnt vmcnt(1)
  v_xor_b32 v26, 96, v240
  buffer_load_dwordx4 v26, s[16:19], s76 offen offset:2048 nt lds
  s_waitcnt vmcnt(1)
  v_xor_b32 v27, 112, v240
  buffer_load_dwordx4 v27, s[16:19], s76 offen offset:3072 nt lds
  s_waitcnt vmcnt(1)
  v_xor_b32 v24, 128, v240
  s_add_u32 s75, s31, 8192
  s_mov_b32 m0, s75
  s_add_u32 s76, s30, 8192
  buffer_load_dwordx4 v24, s[16:19], s76 offen offset:0 nt lds
  s_waitcnt vmcnt(1)
  v_xor_b32 v25, 144, v240
  buffer_load_dwordx4 v25, s[16:19], s76 offen offset:1024 nt lds
  s_waitcnt vmcnt(1)
  v_xor_b32 v26, 160, v240
  buffer_load_dwordx4 v26, s[16:19], s76 offen offset:2048 nt lds
  s_waitcnt vmcnt(1)
  v_xor_b32 v27, 176, v240
  buffer_load_dwordx4 v27, s[16:19], s76 offen offset:3072 nt lds
  s_waitcnt vmcnt(1)
  v_xor_b32 v24, 192, v240
  s_add_u32 s75, s31, 12288
  s_mov_b32 m0, s75
  s_add_u32 s76, s30, 12288
  buffer_load_dwordx4 v24, s[16:19], s76 offen offset:0 nt lds
  s_waitcnt vmcnt(1)
  v_xor_b32 v25, 208, v240
  buffer_load_dwordx4 v25, s[16:19], s76 offen offset:1024 nt lds
  s_waitcnt vmcnt(1)
  v_xor_b32 v26, 224, v240
  buffer_load_dwordx4 v26, s[16:19], s76 offen offset:2048 nt lds
  s_waitcnt vmcnt(1)
  v_xor_b32 v27, 240, v240
  buffer_load_dwordx4 v27, s[16:19], s76 offen offset:3072 nt lds
  s_waitcnt vmcnt(1)
  s_lshr_b32 s79, s2, 6
  s_lshl_b32 s35, s79, 15
  s_lshl_b32 s29, s64, 12
  s_add_u32 s35, s35, s29
  s_add_u32 s35, s35, 65536
  s_lshl_b32 s29, s64, 2
  s_add_u32 s28, s29, 0
  s_and_b32 s75, s28, 15
  s_lshl_b32 s75, s75, 4
  v_xor_b32 v8, s75, v240
  s_lshl_b32 s28, s28, 10
  v_add_u32 v8, s28, v8
  s_add_u32 s28, s29, 1
  s_and_b32 s75, s28, 15
  s_lshl_b32 s75, s75, 4
  v_xor_b32 v9, s75, v240
  s_lshl_b32 s28, s28, 10
  v_add_u32 v9, s28, v9
  s_add_u32 s28, s29, 2
  s_and_b32 s75, s28, 15
  s_lshl_b32 s75, s75, 4
  v_xor_b32 v10, s75, v240
  s_lshl_b32 s28, s28, 10
  v_add_u32 v10, s28, v10
  s_add_u32 s28, s29, 3
  s_and_b32 s75, s28, 15
  s_lshl_b32 s75, s75, 4
  v_xor_b32 v11, s75, v240
  s_lshl_b32 s28, s28, 10
  v_add_u32 v11, s28, v11
  s_mov_b32 s74, 0x8000
L_s2b_tw_15:
  buffer_load_dwordx4 v[64:67], v240, s[4:7], s35 offen offset:0 sc1
  buffer_load_dwordx4 v[68:71], v240, s[4:7], s35 offen offset:1024 sc1
  buffer_load_dwordx4 v[72:75], v240, s[4:7], s35 offen offset:2048 sc1
  buffer_load_dwordx4 v[76:79], v240, s[4:7], s35 offen offset:3072 sc1
  buffer_load_dword v244, v241, s[68:71], 0 offen sc1
  s_waitcnt vmcnt(0)
  v_max3_u32 v243, v64, v65, v66
  v_max3_u32 v243, v67, v68, v243
  v_max3_u32 v243, v69, v70, v243
  v_max3_u32 v243, v71, v72, v243
  v_max3_u32 v243, v73, v74, v243
  v_max3_u32 v243, v75, v76, v243
  v_max3_u32 v243, v77, v78, v243
  v_max_u32 v243, v79, v243
  v_and_b32 v244, 0x10101010, v244
  v_cmp_eq_u32 vcc, -1, v243
  s_mov_b64 s[98:99], vcc
  v_cmp_ne_u32 vcc, 0x10101010, v244
  s_or_b64 vcc, vcc, s[98:99]
  s_cmp_eq_u64 vcc, 0
  s_cbranch_scc1 L_s2b_twd_16
  s_sleep 8
  s_sub_u32 s74, s74, 1
  s_cmp_lg_u32 s74, 0
  s_cbranch_scc1 L_s2b_tw_15
L_s2b_twd_16:
  ds_write_b128 v8, v[64:67] offset:0
  ds_write_b128 v9, v[68:71] offset:0
  ds_write_b128 v10, v[72:75] offset:0
  ds_write_b128 v11, v[76:79] offset:0
  s_waitcnt lgkmcnt(0)
  s_barrier
  v_lshrrev_b32 v2, 4, v1
  v_and_b32 v3, 15, v1
  v_add_u32 v8, 0, v2
  v_xor_b32 v8, v8, v3
  v_lshlrev_b32 v8, 4, v8
  v_lshl_add_u32 v8, v3, 10, v8
  v_add_u32 v9, 4, v2
  v_xor_b32 v9, v9, v3
  v_lshlrev_b32 v9, 4, v9
  v_lshl_add_u32 v9, v3, 10, v9
  v_add_u32 v10, 8, v2
  v_xor_b32 v10, v10, v3
  v_lshlrev_b32 v10, 4, v10
  v_lshl_add_u32 v10, v3, 10, v10
  v_add_u32 v11, 12, v2
  v_xor_b32 v11, v11, v3
  v_lshlrev_b32 v11, 4, v11
  v_lshl_add_u32 v11, v3, 10, v11
  ds_read_b128 v[96:99], v8 offset:0
  ds_read_b128 v[100:103], v9 offset:0
  ds_read_b128 v[104:107], v10 offset:0
  ds_read_b128 v[108:111], v11 offset:0
  ds_read_b128 v[112:115], v8 offset:256
  ds_read_b128 v[116:119], v9 offset:256
  ds_read_b128 v[120:123], v10 offset:256
  ds_read_b128 v[124:127], v11 offset:256
  ds_read_b128 v[128:131], v8 offset:512
  ds_read_b128 v[132:135], v9 offset:512
  ds_read_b128 v[136:139], v10 offset:512
  ds_read_b128 v[140:143], v11 offset:512
  ds_read_b128 v[144:147], v8 offset:768
  ds_read_b128 v[148:151], v9 offset:768
  ds_read_b128 v[152:155], v10 offset:768
  ds_read_b128 v[156:159], v11 offset:768
  ds_read_b128 v[160:163], v8 offset:16384
  ds_read_b128 v[164:167], v9 offset:16384
  ds_read_b128 v[168:171], v10 offset:16384
  ds_read_b128 v[172:175], v11 offset:16384
  ds_read_b128 v[176:179], v8 offset:16640
  ds_read_b128 v[180:183], v9 offset:16640
  ds_read_b128 v[184:187], v10 offset:16640
  ds_read_b128 v[188:191], v11 offset:16640
  ds_read_b128 v[192:195], v8 offset:16896
  ds_read_b128 v[196:199], v9 offset:16896
  ds_read_b128 v[200:203], v10 offset:16896
  ds_read_b128 v[204:207], v11 offset:16896
  ds_read_b128 v[208:211], v8 offset:17152
  ds_read_b128 v[212:215], v9 offset:17152
  ds_read_b128 v[216:219], v10 offset:17152
  ds_read_b128 v[220:223], v11 offset:17152
  s_lshl_b32 s28, s64, 14
  s_add_u32 s28, s28, 32768
  v_add_u32 v12, s28, v8
  v_add_u32 v13, s28, v9
  v_add_u32 v14, s28, v10
  v_add_u32 v15, s28, v11
  s_waitcnt lgkmcnt(0)
  s_barrier
  ds_read_b128 v[72:75], v12 offset:0
  ds_read_b128 v[76:79], v13 offset:0
  ds_read_b128 v[80:83], v14 offset:0
  ds_read_b128 v[84:87], v15 offset:0
  s_waitcnt lgkmcnt(3)
  v_mfma_f32_16x16x32_bf16 v[64:67], v[72:75], v[96:99], 0
  v_mfma_f32_16x16x32_bf16 v[68:71], v[72:75], v[160:163], 0
  ds_read_b128 v[72:75], v12 offset:256
  s_waitcnt lgkmcnt(3)
  v_mfma_f32_16x16x32_bf16 v[64:67], v[76:79], v[100:103], v[64:67]
  v_mfma_f32_16x16x32_bf16 v[68:71], v[76:79], v[164:167], v[68:71]
  ds_read_b128 v[76:79], v13 offset:256
  s_waitcnt lgkmcnt(3)
  v_mfma_f32_16x16x32_bf16 v[64:67], v[80:83], v[104:107], v[64:67]
  v_mfma_f32_16x16x32_bf16 v[68:71], v[80:83], v[168:171], v[68:71]
  ds_read_b128 v[80:83], v14 offset:256
  s_waitcnt lgkmcnt(3)
  v_mfma_f32_16x16x32_bf16 v[64:67], v[84:87], v[108:111], v[64:67]
  v_mfma_f32_16x16x32_bf16 v[68:71], v[84:87], v[172:175], v[68:71]
  ds_read_b128 v[84:87], v15 offset:256
  s_waitcnt lgkmcnt(3)
  v_mfma_f32_16x16x32_bf16 v[64:67], v[72:75], v[112:115], v[64:67]
  v_mfma_f32_16x16x32_bf16 v[68:71], v[72:75], v[176:179], v[68:71]
  ds_read_b128 v[72:75], v12 offset:512
  s_waitcnt lgkmcnt(3)
  v_mfma_f32_16x16x32_bf16 v[64:67], v[76:79], v[116:119], v[64:67]
  v_mfma_f32_16x16x32_bf16 v[68:71], v[76:79], v[180:183], v[68:71]
  ds_read_b128 v[76:79], v13 offset:512
  s_waitcnt lgkmcnt(3)
  v_mfma_f32_16x16x32_bf16 v[64:67], v[80:83], v[120:123], v[64:67]
  v_mfma_f32_16x16x32_bf16 v[68:71], v[80:83], v[184:187], v[68:71]
  ds_read_b128 v[80:83], v14 offset:512
  s_waitcnt lgkmcnt(3)
  v_mfma_f32_16x16x32_bf16 v[64:67], v[84:87], v[124:127], v[64:67]
  v_mfma_f32_16x16x32_bf16 v[68:71], v[84:87], v[188:191], v[68:71]
  ds_read_b128 v[84:87], v15 offset:512
  s_waitcnt lgkmcnt(3)
  v_mfma_f32_16x16x32_bf16 v[64:67], v[72:75], v[128:131], v[64:67]
  v_mfma_f32_16x16x32_bf16 v[68:71], v[72:75], v[192:195], v[68:71]
  ds_read_b128 v[72:75], v12 offset:768
  s_waitcnt lgkmcnt(3)
  v_mfma_f32_16x16x32_bf16 v[64:67], v[76:79], v[132:135], v[64:67]
  v_mfma_f32_16x16x32_bf16 v[68:71], v[76:79], v[196:199], v[68:71]
  ds_read_b128 v[76:79], v13 offset:768
  s_waitcnt lgkmcnt(3)
  v_mfma_f32_16x16x32_bf16 v[64:67], v[80:83], v[136:139], v[64:67]
  v_mfma_f32_16x16x32_bf16 v[68:71], v[80:83], v[200:203], v[68:71]
  ds_read_b128 v[80:83], v14 offset:768
  s_waitcnt lgkmcnt(3)
  v_mfma_f32_16x16x32_bf16 v[64:67], v[84:87], v[140:143], v[64:67]
  v_mfma_f32_16x16x32_bf16 v[68:71], v[84:87], v[204:207], v[68:71]
  ds_read_b128 v[84:87], v15 offset:768
  s_waitcnt lgkmcnt(3)
  v_mfma_f32_16x16x32_bf16 v[64:67], v[72:75], v[144:147], v[64:67]
  v_mfma_f32_16x16x32_bf16 v[68:71], v[72:75], v[208:211], v[68:71]
  s_waitcnt lgkmcnt(2)
  v_mfma_f32_16x16x32_bf16 v[64:67], v[76:79], v[148:151], v[64:67]
  v_mfma_f32_16x16x32_bf16 v[68:71], v[76:79], v[212:215], v[68:71]
  s_waitcnt lgkmcnt(1)
  v_mfma_f32_16x16x32_bf16 v[64:67], v[80:83], v[152:155], v[64:67]
  v_mfma_f32_16x16x32_bf16 v[68:71], v[80:83], v[216:219], v[68:71]
  s_waitcnt lgkmcnt(0)
  v_mfma_f32_16x16x32_bf16 v[64:67], v[84:87], v[156:159], v[64:67]
  v_mfma_f32_16x16x32_bf16 v[68:71], v[84:87], v[220:223], v[68:71]
  v_lshrrev_b32 v4, 2, v3
  v_and_b32 v5, 3, v3
  v_lshrrev_b32 v6, 1, v2
  v_lshl_add_u32 v6, v6, 2, v4
  v_and_b32 v7, 1, v2
  v_lshlrev_b32 v7, 1, v7
  v_lshrrev_b32 v24, 1, v5
  v_add_u32 v7, v7, v24
  v_and_b32 v5, 1, v5
  v_lshlrev_b32 v5, 3, v5
  s_and_b32 s28, s64, 1
  s_lshl_b32 s28, s28, 3
  s_lshr_b32 s29, s64, 1
  s_lshl_b32 s29, s29, 8
  s_add_u32 s29, s29, 32768
  v_add_u32 v24, 0, v6
  v_add3_u32 v16, v7, s28, 0
  v_xor_b32 v16, v16, v24
  v_lshlrev_b32 v16, 4, v16
  v_lshl_add_u32 v16, v24, 10, v16
  v_add3_u32 v16, v16, v5, s29
  v_add_u32 v20, 0x10000, v16
  v_add_u32 v24, 8, v6
  v_add3_u32 v17, v7, s28, 0
  v_xor_b32 v17, v17, v24
  v_lshlrev_b32 v17, 4, v17
  v_lshl_add_u32 v17, v24, 10, v17
  v_add3_u32 v17, v17, v5, s29
  v_add_u32 v21, 0x10000, v17
  v_add_u32 v24, 0, v6
  v_add3_u32 v18, v7, s28, 4
  v_xor_b32 v18, v18, v24
  v_lshlrev_b32 v18, 4, v18
  v_lshl_add_u32 v18, v24, 10, v18
  v_add3_u32 v18, v18, v5, s29
  v_add_u32 v22, 0x10000, v18
  v_add_u32 v24, 8, v6
  v_add3_u32 v19, v7, s28, 4
  v_xor_b32 v19, v19, v24
  v_lshlrev_b32 v19, 4, v19
  v_lshl_add_u32 v19, v24, 10, v19
  v_add3_u32 v19, v19, v5, s29
  v_add_u32 v23, 0x10000, v19
  v_cvt_pk_bf16_f32 v24, v64, v65
  v_cvt_pk_bf16_f32 v25, v66, v67
  v_cvt_pk_bf16_f32 v26, v68, v69
  v_cvt_pk_bf16_f32 v27, v70, v71
  v_lshlrev_b32 v64, 16, v24
  v_and_b32 v65, 0xffff0000, v24
  v_lshlrev_b32 v66, 16, v25
  v_and_b32 v67, 0xffff0000, v25
  v_lshlrev_b32 v68, 16, v26
  v_and_b32 v69, 0xffff0000, v26
  v_lshlrev_b32 v70, 16, v27
  v_and_b32 v71, 0xffff0000, v27
  v_mul_f32 v64, 0x3db504f3, v64
  v_mul_f32 v65, 0x3db504f3, v65
  v_mul_f32 v66, 0x3db504f3, v66
  v_mul_f32 v67, 0x3db504f3, v67
  v_mul_f32 v68, 0x3db504f3, v68
  v_mul_f32 v69, 0x3db504f3, v69
  v_mul_f32 v70, 0x3db504f3, v70
  v_mul_f32 v71, 0x3db504f3, v71
  v_cvt_pk_bf16_f32 v24, v64, v65
  v_cvt_pk_bf16_f32 v25, v66, v67
  v_cvt_pk_bf16_f32 v26, v68, v69
  v_cvt_pk_bf16_f32 v27, v70, v71
  v_lshlrev_b32 v64, 16, v24
  v_and_b32 v65, 0xffff0000, v24
  v_lshlrev_b32 v66, 16, v25
  v_and_b32 v67, 0xffff0000, v25
  v_lshlrev_b32 v68, 16, v26
  v_and_b32 v69, 0xffff0000, v26
  v_lshlrev_b32 v70, 16, v27
  v_and_b32 v71, 0xffff0000, v27
  v_max3_f32 v28, v64, v65, v66
  v_max_f32 v28, v28, v67
  v_max3_f32 v29, v68, v69, v70
  v_max_f32 v29, v29, v71
  v_mov_b32 v30, v28
  v_mov_b32 v31, v29
  s_nop 1
  v_permlane16_swap_b32 v28, v30
  v_permlane16_swap_b32 v29, v31
  v_max_f32 v28, v28, v30
  v_max_f32 v29, v29, v31
  v_mov_b32 v30, v28
  v_mov_b32 v31, v29
  s_nop 1
  v_permlane32_swap_b32 v28, v30
  v_permlane32_swap_b32 v29, v31
  v_max_f32 v28, v28, v30
  v_max_f32 v29, v29, v31
  s_lshl_b32 s28, s64, 7
  v_lshlrev_b32 v4, 2, v3
  v_add_u32 v5, s28, v4
  v_cmp_gt_u32 vcc, 16, v1
  s_and_saveexec_b64 s[72:73], vcc
  ds_write_b32 v5, v28 offset:0
  ds_write_b32 v5, v29 offset:64
  s_mov_b64 exec, s[72:73]
  s_waitcnt lgkmcnt(0)
  s_barrier
  ds_read_b32 v72, v4 offset:0
  ds_read_b32 v73, v4 offset:128
  ds_read_b32 v74, v4 offset:256
  ds_read_b32 v75, v4 offset:384
  ds_read_b32 v76, v4 offset:512
  ds_read_b32 v77, v4 offset:640
  ds_read_b32 v78, v4 offset:768
  ds_read_b32 v79, v4 offset:896
  ds_read_b32 v80, v4 offset:64
  ds_read_b32 v81, v4 offset:192
  ds_read_b32 v82, v4 offset:320
  ds_read_b32 v83, v4 offset:448
  ds_read_b32 v84, v4 offset:576
  ds_read_b32 v85, v4 offset:704
  ds_read_b32 v86, v4 offset:832
  ds_read_b32 v87, v4 offset:960
  s_waitcnt lgkmcnt(0)
  v_max3_f32 v28, v72, v73, v74
  v_max3_f32 v28, v75, v76, v28
  v_max3_f32 v28, v77, v78, v28
  v_max_f32 v28, v79, v28
  v_max3_f32 v29, v80, v81, v82
  v_max3_f32 v29, v83, v84, v29
  v_max3_f32 v29, v85, v86, v29
  v_max_f32 v29, v87, v29
  v_sub_f32 v64, v64, v28
  v_sub_f32 v65, v65, v28
  v_sub_f32 v66, v66, v28
  v_sub_f32 v67, v67, v28
  v_sub_f32 v68, v68, v29
  v_sub_f32 v69, v69, v29
  v_sub_f32 v70, v70, v29
  v_sub_f32 v71, v71, v29
  v_mul_f32 v64, 0x3fb8aa3b, v64
  v_mul_f32 v65, 0x3fb8aa3b, v65
  v_mul_f32 v66, 0x3fb8aa3b, v66
  v_mul_f32 v67, 0x3fb8aa3b, v67
  v_mul_f32 v68, 0x3fb8aa3b, v68
  v_mul_f32 v69, 0x3fb8aa3b, v69
  v_mul_f32 v70, 0x3fb8aa3b, v70
  v_mul_f32 v71, 0x3fb8aa3b, v71
  v_exp_f32 v64, v64
  v_exp_f32 v65, v65
  v_exp_f32 v66, v66
  v_exp_f32 v67, v67
  v_exp_f32 v68, v68
  v_exp_f32 v69, v69
  v_exp_f32 v70, v70
  v_exp_f32 v71, v71
  s_nop 0
  v_add_f32 v30, v64, v65
  v_add_f32 v31, v66, v67
  v_add_f32 v30, v30, v31
  v_add_f32 v31, v68, v69
  v_add_f32 v24, v70, v71
  v_add_f32 v31, v31, v24
  v_mov_b32 v24, v30
  v_mov_b32 v25, v31
  s_nop 1
  v_permlane16_swap_b32 v30, v24
  v_permlane16_swap_b32 v31, v25
  v_add_f32 v30, v30, v24
  v_add_f32 v31, v31, v25
  v_mov_b32 v24, v30
  v_mov_b32 v25, v31
  s_nop 1
  v_permlane32_swap_b32 v30, v24
  v_permlane32_swap_b32 v31, v25
  v_add_f32 v30, v30, v24
  v_add_f32 v31, v31, v25
  v_cvt_pk_bf16_f32 v24, v64, v65
  v_cvt_pk_bf16_f32 v25, v66, v67
  v_cvt_pk_bf16_f32 v26, v68, v69
  v_cvt_pk_bf16_f32 v27, v70, v71
  s_lshl_b32 s28, s64, 10
  v_and_b32 v6, 1, v2
  v_lshlrev_b32 v6, 9, v6
  v_lshl_add_u32 v6, v3, 4, v6
  v_lshrrev_b32 v7, 1, v2
  v_lshl_add_u32 v6, v7, 3, v6
  v_add_u32 v6, s28, v6
  ds_write_b64 v6, v[24:25] offset:4096
  ds_write_b64 v6, v[26:27] offset:4352
  v_cmp_gt_u32 vcc, 16, v1
  s_and_saveexec_b64 s[72:73], vcc
  ds_write_b32 v5, v30 offset:1024
  ds_write_b32 v5, v31 offset:1088
  s_mov_b64 exec, s[72:73]
  s_waitcnt lgkmcnt(0)
  s_barrier
  ds_read_b128 v[72:75], v240 offset:4096
  ds_read_b64_tr_b16 v[76:77], v16 offset:0
  ds_read_b64_tr_b16 v[78:79], v17 offset:0
  ds_read_b64_tr_b16 v[80:81], v18 offset:0
  ds_read_b64_tr_b16 v[82:83], v19 offset:0
  ds_read_b128 v[84:87], v240 offset:5120
  ds_read_b64_tr_b16 v[88:89], v16 offset:16384
  ds_read_b64_tr_b16 v[90:91], v17 offset:16384
  ds_read_b64_tr_b16 v[92:93], v18 offset:16384
  ds_read_b64_tr_b16 v[94:95], v19 offset:16384
  s_waitcnt lgkmcnt(5)
  v_mfma_f32_32x32x16_bf16 v[32:47], v[76:79], v[72:75], 0
  v_mfma_f32_32x32x16_bf16 v[48:63], v[80:83], v[72:75], 0
  ds_read_b128 v[72:75], v240 offset:6144
  ds_read_b64_tr_b16 v[76:77], v16 offset:32768
  ds_read_b64_tr_b16 v[78:79], v17 offset:32768
  ds_read_b64_tr_b16 v[80:81], v18 offset:32768
  ds_read_b64_tr_b16 v[82:83], v19 offset:32768
  s_waitcnt lgkmcnt(5)
  v_mfma_f32_32x32x16_bf16 v[32:47], v[88:91], v[84:87], v[32:47]
  v_mfma_f32_32x32x16_bf16 v[48:63], v[92:95], v[84:87], v[48:63]
  ds_read_b128 v[84:87], v240 offset:7168
  ds_read_b64_tr_b16 v[88:89], v16 offset:49152
  ds_read_b64_tr_b16 v[90:91], v17 offset:49152
  ds_read_b64_tr_b16 v[92:93], v18 offset:49152
  ds_read_b64_tr_b16 v[94:95], v19 offset:49152
  s_waitcnt lgkmcnt(5)
  v_mfma_f32_32x32x16_bf16 v[32:47], v[76:79], v[72:75], v[32:47]
  v_mfma_f32_32x32x16_bf16 v[48:63], v[80:83], v[72:75], v[48:63]
  ds_read_b128 v[72:75], v240 offset:8192
  ds_read_b64_tr_b16 v[76:77], v20 offset:0
  ds_read_b64_tr_b16 v[78:79], v21 offset:0
  ds_read_b64_tr_b16 v[80:81], v22 offset:0
  ds_read_b64_tr_b16 v[82:83], v23 offset:0
  s_waitcnt lgkmcnt(5)
  v_mfma_f32_32x32x16_bf16 v[32:47], v[88:91], v[84:87], v[32:47]
  v_mfma_f32_32x32x16_bf16 v[48:63], v[92:95], v[84:87], v[48:63]
  ds_read_b128 v[84:87], v240 offset:9216
  ds_read_b64_tr_b16 v[88:89], v20 offset:16384
  ds_read_b64_tr_b16 v[90:91], v21 offset:16384
  ds_read_b64_tr_b16 v[92:93], v22 offset:16384
  ds_read_b64_tr_b16 v[94:95], v23 offset:16384
  s_waitcnt lgkmcnt(5)
  v_mfma_f32_32x32x16_bf16 v[32:47], v[76:79], v[72:75], v[32:47]
  v_mfma_f32_32x32x16_bf16 v[48:63], v[80:83], v[72:75], v[48:63]
  ds_read_b128 v[72:75], v240 offset:10240
  ds_read_b64_tr_b16 v[76:77], v20 offset:32768
  ds_read_b64_tr_b16 v[78:79], v21 offset:32768
  ds_read_b64_tr_b16 v[80:81], v22 offset:32768
  ds_read_b64_tr_b16 v[82:83], v23 offset:32768
  s_waitcnt lgkmcnt(5)
  v_mfma_f32_32x32x16_bf16 v[32:47], v[88:91], v[84:87], v[32:47]
  v_mfma_f32_32x32x16_bf16 v[48:63], v[92:95], v[84:87], v[48:63]
  ds_read_b128 v[84:87], v240 offset:11264
  ds_read_b64_tr_b16 v[88:89], v20 offset:49152
  ds_read_b64_tr_b16 v[90:91], v21 offset:49152
  ds_read_b64_tr_b16 v[92:93], v22 offset:49152
  ds_read_b64_tr_b16 v[94:95], v23 offset:49152
  s_waitcnt lgkmcnt(5)
  v_mfma_f32_32x32x16_bf16 v[32:47], v[76:79], v[72:75], v[32:47]
  v_mfma_f32_32x32x16_bf16 v[48:63], v[80:83], v[72:75], v[48:63]
  s_waitcnt lgkmcnt(0)
  v_mfma_f32_32x32x16_bf16 v[32:47], v[88:91], v[84:87], v[32:47]
  v_mfma_f32_32x32x16_bf16 v[48:63], v[92:95], v[84:87], v[48:63]
  s_mov_b32 s12, s54
  s_and_b32 s13, s55, 0xffff
  s_mov_b32 s14, 4194304
  s_mov_b32 s15, 0x00020000
  v_lshlrev_b32 v6, 13, v2
  v_lshl_add_u32 v6, v3, 4, v6
  s_lshl_b32 s28, s78, 7
  s_lshl_b32 s29, s64, 4
  s_add_u32 s28, s28, s29
  s_lshl_b32 s28, s28, 13
  s_lshl_b32 s29, s77, 8
  s_add_u32 s28, s28, s29
  buffer_load_dwordx4 v[128:131], v6, s[12:15], s28 offen nt
  s_add_u32 s28, s28, 32768
  buffer_load_dwordx4 v[132:135], v6, s[12:15], s28 offen nt
  s_add_u32 s28, s28, 32768
  buffer_load_dwordx4 v[136:139], v6, s[12:15], s28 offen nt
  s_add_u32 s28, s28, 32768
  buffer_load_dwordx4 v[140:143], v6, s[12:15], s28 offen nt
  s_mov_b32 s8, s56
  s_and_b32 s9, s57, 0xffff
  s_mov_b32 s10, 4194304
  s_mov_b32 s11, 0x00020000
  s_lshl_b32 s28, s77, 7
  s_lshl_b32 s29, s78, 5
  s_add_u32 s28, s28, s29
  s_lshl_b32 s29, s64, 2
  s_add_u32 s28, s28, s29
  s_lshl_b32 s28, s28, 10
  buffer_load_dwordx4 v[144:147], v240, s[8:11], s28 offen offset:0 nt
  buffer_load_dwordx4 v[148:151], v240, s[8:11], s28 offen offset:1024 nt
  buffer_load_dwordx4 v[152:155], v240, s[8:11], s28 offen offset:2048 nt
  buffer_load_dwordx4 v[156:159], v240, s[8:11], s28 offen offset:3072 nt
  s_barrier
  v_and_b32 v6, 31, v1
  v_lshrrev_b32 v7, 5, v1
  v_mul_u32_u24 v6, 1040, v6
  v_lshl_add_u32 v6, v7, 3, v6
  s_lshl_b32 s28, s64, 7
  s_add_u32 s28, s28, 32768
  v_add_u32 v6, s28, v6
  s_nop 7
  v_cvt_pk_bf16_f32 v24, v32, v33
  v_cvt_pk_bf16_f32 v25, v34, v35
  ds_write_b64 v6, v[24:25] offset:0
  v_cvt_pk_bf16_f32 v26, v36, v37
  v_cvt_pk_bf16_f32 v27, v38, v39
  ds_write_b64 v6, v[26:27] offset:16
  v_cvt_pk_bf16_f32 v24, v40, v41
  v_cvt_pk_bf16_f32 v25, v42, v43
  ds_write_b64 v6, v[24:25] offset:32
  v_cvt_pk_bf16_f32 v26, v44, v45
  v_cvt_pk_bf16_f32 v27, v46, v47
  ds_write_b64 v6, v[26:27] offset:48
  v_cvt_pk_bf16_f32 v24, v48, v49
  v_cvt_pk_bf16_f32 v25, v50, v51
  ds_write_b64 v6, v[24:25] offset:64
  v_cvt_pk_bf16_f32 v26, v52, v53
  v_cvt_pk_bf16_f32 v27, v54, v55
  ds_write_b64 v6, v[26:27] offset:80
  v_cvt_pk_bf16_f32 v24, v56, v57
  v_cvt_pk_bf16_f32 v25, v58, v59
  ds_write_b64 v6, v[24:25] offset:96
  v_cvt_pk_bf16_f32 v26, v60, v61
  v_cvt_pk_bf16_f32 v27, v62, v63
  ds_write_b64 v6, v[26:27] offset:112
  s_waitcnt lgkmcnt(0)
  s_barrier
  s_mul_i32 s28, s64, 4160
  s_add_u32 s28, s28, 32768
  v_add_u32 v6, s28, v240
  ds_read_b128 v[72:75], v6 offset:0
  ds_read_b128 v[76:79], v6 offset:1040
  ds_read_b128 v[80:83], v6 offset:2080
  ds_read_b128 v[84:87], v6 offset:3120
  s_lshl_b32 s28, s2, 15
  s_lshl_b32 s29, s64, 12
  s_add_u32 s28, s28, s29
  s_add_u32 s28, s28, 4194304
  s_waitcnt lgkmcnt(0)
  buffer_store_dwordx4 v[72:75], v240, s[4:7], s28 offen offset:0 sc1
  buffer_store_dwordx4 v[76:79], v240, s[4:7], s28 offen offset:1024 sc1
  buffer_store_dwordx4 v[80:83], v240, s[4:7], s28 offen offset:2048 sc1
  buffer_store_dwordx4 v[84:87], v240, s[4:7], s28 offen offset:3072 sc1
  s_cmp_lg_u32 s64, 0
  s_cbranch_scc1 L_s2b_st_17
  ds_read_b32 v88, v4 offset:1024
  ds_read_b32 v96, v4 offset:1088
  ds_read_b32 v89, v4 offset:1152
  ds_read_b32 v97, v4 offset:1216
  ds_read_b32 v90, v4 offset:1280
  ds_read_b32 v98, v4 offset:1344
  ds_read_b32 v91, v4 offset:1408
  ds_read_b32 v99, v4 offset:1472
  ds_read_b32 v92, v4 offset:1536
  ds_read_b32 v100, v4 offset:1600
  ds_read_b32 v93, v4 offset:1664
  ds_read_b32 v101, v4 offset:1728
  ds_read_b32 v94, v4 offset:1792
  ds_read_b32 v102, v4 offset:1856
  ds_read_b32 v95, v4 offset:1920
  ds_read_b32 v103, v4 offset:1984
  s_waitcnt lgkmcnt(0)
  v_add_f32 v88, v88, v89
  v_add_f32 v90, v90, v91
  v_add_f32 v92, v92, v93
  v_add_f32 v94, v94, v95
  v_add_f32 v88, v88, v90
  v_add_f32 v92, v92, v94
  v_add_f32 v88, v88, v92
  v_add_f32 v96, v96, v97
  v_add_f32 v98, v98, v99
  v_add_f32 v100, v100, v101
  v_add_f32 v102, v102, v103
  v_add_f32 v96, v96, v98
  v_add_f32 v100, v100, v102
  v_add_f32 v96, v96, v100
  v_mov_b32 v24, v28
  v_mov_b32 v25, v88
  v_mov_b32 v26, v29
  v_mov_b32 v27, v96
  s_lshl_b32 s28, s2, 8
  s_add_u32 s28, s28, 589824
  v_lshlrev_b32 v6, 3, v3
  v_cmp_gt_u32 vcc, 16, v1
  s_and_saveexec_b64 s[72:73], vcc
  buffer_store_dwordx2 v[24:25], v6, s[4:7], s28 offen sc1
  buffer_store_dwordx2 v[26:27], v6, s[4:7], s28 offen offset:128 sc1
  s_mov_b64 exec, s[72:73]
L_s2b_st_17:
  s_barrier
  v_lshlrev_b32 v4, 8, v1
  s_lshl_b32 s33, s77, 3
  s_add_u32 s33, s33, 589824
  s_lshl_b32 s35, s64, 19
  s_lshl_b32 s29, s77, 10
  s_add_u32 s35, s35, s29
  s_lshl_b32 s29, s78, 8
  s_add_u32 s35, s35, s29
  s_add_u32 s35, s35, 4194304
  s_mov_b32 s74, 0x8000
L_s3b_tw_18:
  buffer_load_dwordx2 v[64:65], v4, s[4:7], s33 offen sc1
  s_add_u32 s28, s33, 16384
  buffer_load_dwordx2 v[66:67], v4, s[4:7], s28 offen sc1
  s_mov_b32 s28, s35
  buffer_load_dword v96, v241, s[4:7], s28 offen sc1
  s_add_u32 s28, s28, 32768
  buffer_load_dword v97, v241, s[4:7], s28 offen sc1
  s_add_u32 s28, s28, 32768
  buffer_load_dword v98, v241, s[4:7], s28 offen sc1
  s_add_u32 s28, s28, 32768
  buffer_load_dword v99, v241, s[4:7], s28 offen sc1
  s_add_u32 s28, s28, 32768
  buffer_load_dword v100, v241, s[4:7], s28 offen sc1
  s_add_u32 s28, s28, 32768
  buffer_load_dword v101, v241, s[4:7], s28 offen sc1
  s_add_u32 s28, s28, 32768
  buffer_load_dword v102, v241, s[4:7], s28 offen sc1
  s_add_u32 s28, s28, 32768
  buffer_load_dword v103, v241, s[4:7], s28 offen sc1
  s_add_u32 s28, s28, 32768
  buffer_load_dword v104, v241, s[4:7], s28 offen sc1
  s_add_u32 s28, s28, 32768
  buffer_load_dword v105, v241, s[4:7], s28 offen sc1
  s_add_u32 s28, s28, 32768
  buffer_load_dword v106, v241, s[4:7], s28 offen sc1
  s_add_u32 s28, s28, 32768
  buffer_load_dword v107, v241, s[4:7], s28 offen sc1
  s_add_u32 s28, s28, 32768
  buffer_load_dword v108, v241, s[4:7], s28 offen sc1
  s_add_u32 s28, s28, 32768
  buffer_load_dword v109, v241, s[4:7], s28 offen sc1
  s_add_u32 s28, s28, 32768
  buffer_load_dword v110, v241, s[4:7], s28 offen sc1
  s_add_u32 s28, s28, 32768
  buffer_load_dword v111, v241, s[4:7], s28 offen sc1
  buffer_load_dword v244, v241, s[68:71], 0 offen sc1
  s_waitcnt vmcnt(0)
  v_max3_u32 v243, v64, v65, v66
  v_max3_u32 v243, v67, v96, v243
  v_max3_u32 v243, v97, v98, v243
  v_max3_u32 v243, v99, v100, v243
  v_max3_u32 v243, v101, v102, v243
  v_max3_u32 v243, v103, v104, v243
  v_max3_u32 v243, v105, v106, v243
  v_max3_u32 v243, v107, v108, v243
  v_max3_u32 v243, v109, v110, v243
  v_max_u32 v243, v111, v243
  v_and_b32 v244, 0x10101010, v244
  v_cmp_eq_u32 vcc, -1, v243
  s_mov_b64 s[98:99], vcc
  v_cmp_ne_u32 vcc, 0x10101010, v244
  s_or_b64 vcc, vcc, s[98:99]
  s_cmp_eq_u64 vcc, 0
  s_cbranch_scc1 L_s3b_twd_19
  s_sleep 8
  s_sub_u32 s74, s74, 1
  s_cmp_lg_u32 s74, 0
  s_cbranch_scc1 L_s3b_tw_18
L_s3b_twd_19:
  v_mov_b32 v24, v64
  v_mov_b32 v25, v66
  s_nop 1
  v_max_f32_dpp v24, v24, v24 row_ror:1 row_mask:0xf bank_mask:0xf
  v_max_f32_dpp v25, v25, v25 row_ror:1 row_mask:0xf bank_mask:0xf
  s_nop 1
  v_max_f32_dpp v24, v24, v24 row_ror:2 row_mask:0xf bank_mask:0xf
  v_max_f32_dpp v25, v25, v25 row_ror:2 row_mask:0xf bank_mask:0xf
  s_nop 1
  v_max_f32_dpp v24, v24, v24 row_ror:4 row_mask:0xf bank_mask:0xf
  v_max_f32_dpp v25, v25, v25 row_ror:4 row_mask:0xf bank_mask:0xf
  s_nop 1
  v_max_f32_dpp v24, v24, v24 row_ror:8 row_mask:0xf bank_mask:0xf
  v_max_f32_dpp v25, v25, v25 row_ror:8 row_mask:0xf bank_mask:0xf
  s_nop 1
  v_mov_b32 v26, v24
  v_mov_b32 v27, v25
  s_nop 1
  v_permlane16_swap_b32 v24, v26
  v_permlane16_swap_b32 v25, v27
  v_max_f32 v24, v24, v26
  v_max_f32 v25, v25, v27
  v_mov_b32 v26, v24
  v_mov_b32 v27, v25
  s_nop 1
  v_permlane32_swap_b32 v24, v26
  v_permlane32_swap_b32 v25, v27
  v_max_f32 v24, v24, v26
  v_max_f32 v25, v25, v27
  v_sub_f32 v64, v64, v24
  v_sub_f32 v66, v66, v25
  v_mul_f32 v64, 0x3fb8aa3b, v64
  v_mul_f32 v66, 0x3fb8aa3b, v66
  v_exp_f32 v64, v64
  v_exp_f32 v66, v66
  s_nop 0
  v_mul_f32 v24, v64, v65
  v_mul_f32 v25, v66, v67
  s_nop 1
  v_add_f32_dpp v24, v24, v24 row_ror:1 row_mask:0xf bank_mask:0xf
  v_add_f32_dpp v25, v25, v25 row_ror:1 row_mask:0xf bank_mask:0xf
  s_nop 1
  v_add_f32_dpp v24, v24, v24 row_ror:2 row_mask:0xf bank_mask:0xf
  v_add_f32_dpp v25, v25, v25 row_ror:2 row_mask:0xf bank_mask:0xf
  s_nop 1
  v_add_f32_dpp v24, v24, v24 row_ror:4 row_mask:0xf bank_mask:0xf
  v_add_f32_dpp v25, v25, v25 row_ror:4 row_mask:0xf bank_mask:0xf
  s_nop 1
  v_add_f32_dpp v24, v24, v24 row_ror:8 row_mask:0xf bank_mask:0xf
  v_add_f32_dpp v25, v25, v25 row_ror:8 row_mask:0xf bank_mask:0xf
  s_nop 1
  v_mov_b32 v26, v24
  v_mov_b32 v27, v25
  s_nop 1
  v_permlane16_swap_b32 v24, v26
  v_permlane16_swap_b32 v25, v27
  v_add_f32 v24, v24, v26
  v_add_f32 v25, v25, v27
  v_mov_b32 v26, v24
  v_mov_b32 v27, v25
  s_nop 1
  v_permlane32_swap_b32 v24, v26
  v_permlane32_swap_b32 v25, v27
  v_add_f32 v24, v24, v26
  v_add_f32 v25, v25, v27
  v_rcp_f32 v24, v24
  v_rcp_f32 v25, v25
  s_nop 0
  v_mul_f32 v64, v64, v24
  v_mul_f32 v66, v66, v25
  s_lshr_b32 s28, s64, 2
  s_cmp_eq_u32 s28, 0
  s_cbranch_scc1 L_s3b_selb_20
  v_mov_b32 v64, v66
L_s3b_selb_20:
  s_and_b32 s28, s64, 3
  s_lshl_b32 s28, s28, 4
  s_nop 0
  v_readlane_b32 s80, v64, s28
  s_add_u32 s28, s28, 1
  v_readlane_b32 s81, v64, s28
  s_add_u32 s28, s28, 1
  v_readlane_b32 s82, v64, s28
  s_add_u32 s28, s28, 1
  v_readlane_b32 s83, v64, s28
  s_add_u32 s28, s28, 1
  v_readlane_b32 s84, v64, s28
  s_add_u32 s28, s28, 1
  v_readlane_b32 s85, v64, s28
  s_add_u32 s28, s28, 1
  v_readlane_b32 s86, v64, s28
  s_add_u32 s28, s28, 1
  v_readlane_b32 s87, v64, s28
  s_add_u32 s28, s28, 1
  v_readlane_b32 s88, v64, s28
  s_add_u32 s28, s28, 1
  v_readlane_b32 s89, v64, s28
  s_add_u32 s28, s28, 1
  v_readlane_b32 s90, v64, s28
  s_add_u32 s28, s28, 1
  v_readlane_b32 s91, v64, s28
  s_add_u32 s28, s28, 1
  v_readlane_b32 s92, v64, s28
  s_add_u32 s28, s28, 1
  v_readlane_b32 s93, v64, s28
  s_add_u32 s28, s28, 1
  v_readlane_b32 s94, v64, s28
  s_add_u32 s28, s28, 1
  v_readlane_b32 s95, v64, s28
  v_mov_b32 v28, 0
  v_mov_b32 v29, 0
  v_lshlrev_b32 v30, 16, v96
  v_and_b32 v31, 0xffff0000, v96
  v_fmac_f32 v28, s80, v30
  v_fmac_f32 v29, s80, v31
  v_lshlrev_b32 v30, 16, v97
  v_and_b32 v31, 0xffff0000, v97
  v_fmac_f32 v28, s81, v30
  v_fmac_f32 v29, s81, v31
  v_lshlrev_b32 v30, 16, v98
  v_and_b32 v31, 0xffff0000, v98
  v_fmac_f32 v28, s82, v30
  v_fmac_f32 v29, s82, v31
  v_lshlrev_b32 v30, 16, v99
  v_and_b32 v31, 0xffff0000, v99
  v_fmac_f32 v28, s83, v30
  v_fmac_f32 v29, s83, v31
  v_lshlrev_b32 v30, 16, v100
  v_and_b32 v31, 0xffff0000, v100
  v_fmac_f32 v28, s84, v30
  v_fmac_f32 v29, s84, v31
  v_lshlrev_b32 v30, 16, v101
  v_and_b32 v31, 0xffff0000, v101
  v_fmac_f32 v28, s85, v30
  v_fmac_f32 v29, s85, v31
  v_lshlrev_b32 v30, 16, v102
  v_and_b32 v31, 0xffff0000, v102
  v_fmac_f32 v28, s86, v30
  v_fmac_f32 v29, s86, v31
  v_lshlrev_b32 v30, 16, v103
  v_and_b32 v31, 0xffff0000, v103
  v_fmac_f32 v28, s87, v30
  v_fmac_f32 v29, s87, v31
  v_lshlrev_b32 v30, 16, v104
  v_and_b32 v31, 0xffff0000, v104
  v_fmac_f32 v28, s88, v30
  v_fmac_f32 v29, s88, v31
  v_lshlrev_b32 v30, 16, v105
  v_and_b32 v31, 0xffff0000, v105
  v_fmac_f32 v28, s89, v30
  v_fmac_f32 v29, s89, v31
  v_lshlrev_b32 v30, 16, v106
  v_and_b32 v31, 0xffff0000, v106
  v_fmac_f32 v28, s90, v30
  v_fmac_f32 v29, s90, v31
  v_lshlrev_b32 v30, 16, v107
  v_and_b32 v31, 0xffff0000, v107
  v_fmac_f32 v28, s91, v30
  v_fmac_f32 v29, s91, v31
  v_lshlrev_b32 v30, 16, v108
  v_and_b32 v31, 0xffff0000, v108
  v_fmac_f32 v28, s92, v30
  v_fmac_f32 v29, s92, v31
  v_lshlrev_b32 v30, 16, v109
  v_and_b32 v31, 0xffff0000, v109
  v_fmac_f32 v28, s93, v30
  v_fmac_f32 v29, s93, v31
  v_lshlrev_b32 v30, 16, v110
  v_and_b32 v31, 0xffff0000, v110
  v_fmac_f32 v28, s94, v30
  v_fmac_f32 v29, s94, v31
  v_lshlrev_b32 v30, 16, v111
  v_and_b32 v31, 0xffff0000, v111
  v_fmac_f32 v28, s95, v30
  v_fmac_f32 v29, s95, v31
  s_lshl_b32 s28, s64, 9
  v_lshlrev_b32 v6, 3, v1
  v_add_u32 v6, s28, v6
  ds_write_b64 v6, v[28:29] offset:0
  s_waitcnt lgkmcnt(0)
  s_barrier
  s_cmp_ge_u32 s64, 4
  s_cbranch_scc1 L_s3b_sk1_21
  v_lshrrev_b32 v6, 7, v0
  v_lshlrev_b32 v6, 11, v6
  v_and_b32 v7, 127, v0
  v_lshl_add_u32 v6, v7, 2, v6
  ds_read_b32 v48, v6 offset:0
  ds_read_b32 v49, v6 offset:512
  ds_read_b32 v50, v6 offset:1024
  ds_read_b32 v51, v6 offset:1536
  s_waitcnt lgkmcnt(0)
  v_add_f32 v48, v48, v49
  v_add_f32 v50, v50, v51
  v_add_f32 v48, v48, v50
  v_lshlrev_b32 v6, 2, v0
  ds_write_b32 v6, v48 offset:4096
  s_waitcnt lgkmcnt(0)
L_s3b_sk1_21:
  s_barrier
  v_lshrrev_b32 v2, 4, v1
  v_and_b32 v3, 15, v1
  s_lshl_b32 s28, s64, 6
  v_lshlrev_b32 v6, 2, v2
  v_add_u32 v6, s28, v6
  ds_read_b32 v16, v6 offset:4096
  ds_read_b32 v17, v6 offset:4112
  ds_read_b32 v18, v6 offset:4128
  ds_read_b32 v19, v6 offset:4144
  ds_read_b32 v20, v6 offset:4608
  ds_read_b32 v21, v6 offset:4624
  ds_read_b32 v22, v6 offset:4640
  ds_read_b32 v23, v6 offset:4656
  v_mov_b32 v32, 0
  v_mov_b32 v33, 0
  v_mov_b32 v34, 0
  v_mov_b32 v35, 0
  v_mov_b32 v36, 0
  v_mov_b32 v37, 0
  v_mov_b32 v38, 0
  v_mov_b32 v39, 0
  v_mov_b32 v40, 0
  v_mov_b32 v41, 0
  v_mov_b32 v42, 0
  v_mov_b32 v43, 0
  v_mov_b32 v44, 0
  v_mov_b32 v45, 0
  v_mov_b32 v46, 0
  v_mov_b32 v47, 0
  s_waitcnt lgkmcnt(0)
  v_lshlrev_b32 v30, 16, v128
  v_and_b32 v31, 0xffff0000, v128
  v_fmac_f32 v32, v30, v16
  v_fmac_f32 v33, v31, v16
  v_fmac_f32 v40, v30, v20
  v_fmac_f32 v41, v31, v20
  v_lshlrev_b32 v30, 16, v129
  v_and_b32 v31, 0xffff0000, v129
  v_fmac_f32 v34, v30, v16
  v_fmac_f32 v35, v31, v16
  v_fmac_f32 v42, v30, v20
  v_fmac_f32 v43, v31, v20
  v_lshlrev_b32 v30, 16, v130
  v_and_b32 v31, 0xffff0000, v130
  v_fmac_f32 v36, v30, v16
  v_fmac_f32 v37, v31, v16
  v_fmac_f32 v44, v30, v20
  v_fmac_f32 v45, v31, v20
  v_lshlrev_b32 v30, 16, v131
  v_and_b32 v31, 0xffff0000, v131
  v_fmac_f32 v38, v30, v16
  v_fmac_f32 v39, v31, v16
  v_fmac_f32 v46, v30, v20
  v_fmac_f32 v47, v31, v20
  v_lshlrev_b32 v30, 16, v132
  v_and_b32 v31, 0xffff0000, v132
  v_fmac_f32 v32, v30, v17
  v_fmac_f32 v33, v31, v17
  v_fmac_f32 v40, v30, v21
  v_fmac_f32 v41, v31, v21
  v_lshlrev_b32 v30, 16, v133
  v_and_b32 v31, 0xffff0000, v133
  v_fmac_f32 v34, v30, v17
  v_fmac_f32 v35, v31, v17
  v_fmac_f32 v42, v30, v21
  v_fmac_f32 v43, v31, v21
  v_lshlrev_b32 v30, 16, v134
  v_and_b32 v31, 0xffff0000, v134
  v_fmac_f32 v36, v30, v17
  v_fmac_f32 v37, v31, v17
  v_fmac_f32 v44, v30, v21
  v_fmac_f32 v45, v31, v21
  v_lshlrev_b32 v30, 16, v135
  v_and_b32 v31, 0xffff0000, v135
  v_fmac_f32 v38, v30, v17
  v_fmac_f32 v39, v31, v17
  v_fmac_f32 v46, v30, v21
  v_fmac_f32 v47, v31, v21
  v_lshlrev_b32 v30, 16, v136
  v_and_b32 v31, 0xffff0000, v136
  v_fmac_f32 v32, v30, v18
  v_fmac_f32 v33, v31, v18
  v_fmac_f32 v40, v30, v22
  v_fmac_f32 v41, v31, v22
  v_lshlrev_b32 v30, 16, v137
  v_and_b32 v31, 0xffff0000, v137
  v_fmac_f32 v34, v30, v18
  v_fmac_f32 v35, v31, v18
  v_fmac_f32 v42, v30, v22
  v_fmac_f32 v43, v31, v22
  v_lshlrev_b32 v30, 16, v138
  v_and_b32 v31, 0xffff0000, v138
  v_fmac_f32 v36, v30, v18
  v_fmac_f32 v37, v31, v18
  v_fmac_f32 v44, v30, v22
  v_fmac_f32 v45, v31, v22
  v_lshlrev_b32 v30, 16, v139
  v_and_b32 v31, 0xffff0000, v139
  v_fmac_f32 v38, v30, v18
  v_fmac_f32 v39, v31, v18
  v_fmac_f32 v46, v30, v22
  v_fmac_f32 v47, v31, v22
  v_lshlrev_b32 v30, 16, v140
  v_and_b32 v31, 0xffff0000, v140
  v_fmac_f32 v32, v30, v19
  v_fmac_f32 v33, v31, v19
  v_fmac_f32 v40, v30, v23
  v_fmac_f32 v41, v31, v23
  v_lshlrev_b32 v30, 16, v141
  v_and_b32 v31, 0xffff0000, v141
  v_fmac_f32 v34, v30, v19
  v_fmac_f32 v35, v31, v19
  v_fmac_f32 v42, v30, v23
  v_fmac_f32 v43, v31, v23
  v_lshlrev_b32 v30, 16, v142
  v_and_b32 v31, 0xffff0000, v142
  v_fmac_f32 v36, v30, v19
  v_fmac_f32 v37, v31, v19
  v_fmac_f32 v44, v30, v23
  v_fmac_f32 v45, v31, v23
  v_lshlrev_b32 v30, 16, v143
  v_and_b32 v31, 0xffff0000, v143
  v_fmac_f32 v38, v30, v19
  v_fmac_f32 v39, v31, v19
  v_fmac_f32 v46, v30, v23
  v_fmac_f32 v47, v31, v23
  v_mov_b32 v48, v32
  v_mov_b32 v49, v33
  v_mov_b32 v50, v34
  v_mov_b32 v51, v35
  v_mov_b32 v52, v36
  v_mov_b32 v53, v37
  v_mov_b32 v54, v38
  v_mov_b32 v55, v39
  v_mov_b32 v56, v40
  v_mov_b32 v57, v41
  v_mov_b32 v58, v42
  v_mov_b32 v59, v43
  v_mov_b32 v60, v44
  v_mov_b32 v61, v45
  v_mov_b32 v62, v46
  v_mov_b32 v63, v47
  v_permlane16_swap_b32 v32, v48
  v_permlane16_swap_b32 v33, v49
  v_permlane16_swap_b32 v34, v50
  v_permlane16_swap_b32 v35, v51
  v_permlane16_swap_b32 v36, v52
  v_permlane16_swap_b32 v37, v53
  v_permlane16_swap_b32 v38, v54
  v_permlane16_swap_b32 v39, v55
  v_permlane16_swap_b32 v40, v56
  v_permlane16_swap_b32 v41, v57
  v_permlane16_swap_b32 v42, v58
  v_permlane16_swap_b32 v43, v59
  v_permlane16_swap_b32 v44, v60
  v_permlane16_swap_b32 v45, v61
  v_permlane16_swap_b32 v46, v62
  v_permlane16_swap_b32 v47, v63
  v_add_f32 v32, v32, v48
  v_add_f32 v33, v33, v49
  v_add_f32 v34, v34, v50
  v_add_f32 v35, v35, v51
  v_add_f32 v36, v36, v52
  v_add_f32 v37, v37, v53
  v_add_f32 v38, v38, v54
  v_add_f32 v39, v39, v55
  v_add_f32 v40, v40, v56
  v_add_f32 v41, v41, v57
  v_add_f32 v42, v42, v58
  v_add_f32 v43, v43, v59
  v_add_f32 v44, v44, v60
  v_add_f32 v45, v45, v61
  v_add_f32 v46, v46, v62
  v_add_f32 v47, v47, v63
  v_mov_b32 v48, v32
  v_mov_b32 v49, v33
  v_mov_b32 v50, v34
  v_mov_b32 v51, v35
  v_mov_b32 v52, v36
  v_mov_b32 v53, v37
  v_mov_b32 v54, v38
  v_mov_b32 v55, v39
  v_mov_b32 v56, v40
  v_mov_b32 v57, v41
  v_mov_b32 v58, v42
  v_mov_b32 v59, v43
  v_mov_b32 v60, v44
  v_mov_b32 v61, v45
  v_mov_b32 v62, v46
  v_mov_b32 v63, v47
  v_permlane32_swap_b32 v32, v48
  v_permlane32_swap_b32 v33, v49
  v_permlane32_swap_b32 v34, v50
  v_permlane32_swap_b32 v35, v51
  v_permlane32_swap_b32 v36, v52
  v_permlane32_swap_b32 v37, v53
  v_permlane32_swap_b32 v38, v54
  v_permlane32_swap_b32 v39, v55
  v_permlane32_swap_b32 v40, v56
  v_permlane32_swap_b32 v41, v57
  v_permlane32_swap_b32 v42, v58
  v_permlane32_swap_b32 v43, v59
  v_permlane32_swap_b32 v44, v60
  v_permlane32_swap_b32 v45, v61
  v_permlane32_swap_b32 v46, v62
  v_permlane32_swap_b32 v47, v63
  v_add_f32 v32, v32, v48
  v_add_f32 v33, v33, v49
  v_add_f32 v34, v34, v50
  v_add_f32 v35, v35, v51
  v_add_f32 v36, v36, v52
  v_add_f32 v37, v37, v53
  v_add_f32 v38, v38, v54
  v_add_f32 v39, v39, v55
  v_add_f32 v40, v40, v56
  v_add_f32 v41, v41, v57
  v_add_f32 v42, v42, v58
  v_add_f32 v43, v43, v59
  v_add_f32 v44, v44, v60
  v_add_f32 v45, v45, v61
  v_add_f32 v46, v46, v62
  v_add_f32 v47, v47, v63
  s_lshl_b32 s29, s64, 10
  v_lshlrev_b32 v6, 6, v1
  v_add_u32 v6, s29, v6
  v_cmp_gt_u32 vcc, 16, v1
  s_and_saveexec_b64 s[72:73], vcc
  ds_write_b128 v6, v[32:35] offset:8192
  ds_write_b128 v6, v[36:39] offset:8208
  ds_write_b128 v6, v[40:43] offset:8224
  ds_write_b128 v6, v[44:47] offset:8240
  s_mov_b64 exec, s[72:73]
  s_waitcnt lgkmcnt(0)
  s_barrier
  s_cmp_ge_u32 s64, 4
  s_cbranch_scc1 L_s3b_sk2_22
  v_and_b32 v24, 127, v0
  v_lshrrev_b32 v25, 7, v0
  v_lshrrev_b32 v26, 3, v24
  v_lshlrev_b32 v26, 6, v26
  v_and_b32 v27, 7, v24
  v_lshl_add_u32 v27, v25, 3, v27
  v_lshl_add_u32 v26, v27, 2, v26
  ds_read_b32 v48, v26 offset:8192
  ds_read_b32 v49, v26 offset:9216
  ds_read_b32 v50, v26 offset:10240
  ds_read_b32 v51, v26 offset:11264
  ds_read_b32 v52, v26 offset:12288
  ds_read_b32 v53, v26 offset:13312
  ds_read_b32 v54, v26 offset:14336
  ds_read_b32 v55, v26 offset:15360
  s_waitcnt lgkmcnt(0)
  v_add_f32 v48, v48, v49
  v_add_f32 v50, v50, v51
  v_add_f32 v52, v52, v53
  v_add_f32 v54, v54, v55
  v_add_f32 v48, v48, v50
  v_add_f32 v52, v52, v54
  v_add_f32 v48, v48, v52
  s_lshl_b32 s28, s77, 2
  s_add_u32 s28, s28, s78
  s_lshl_b32 s28, s28, 10
  s_add_u32 s28, s28, 655360
  v_lshlrev_b32 v6, 2, v0
  buffer_store_dword v48, v6, s[4:7], s28 offen sc1
L_s3b_sk2_22:
  v_and_b32 v2, 7, v1
  v_lshrrev_b32 v3, 2, v2
  v_lshlrev_b32 v4, 9, v3
  v_and_b32 v3, 3, v2
  v_lshl_add_u32 v4, v3, 2, v4
  s_lshl_b32 s35, s77, 12
  s_lshl_b32 s29, s78, 7
  s_add_u32 s35, s35, s29
  s_lshl_b32 s29, s64, 4
  s_add_u32 s35, s35, s29
  s_add_u32 s35, s35, 655360
  s_mov_b32 s74, 0x8000
L_s3bii_tw_23:
  buffer_load_dword v64, v4, s[4:7], s35 offen offset:0 sc1
  buffer_load_dword v65, v4, s[4:7], s35 offen offset:1024 sc1
  buffer_load_dword v66, v4, s[4:7], s35 offen offset:2048 sc1
  buffer_load_dword v67, v4, s[4:7], s35 offen offset:3072 sc1
  buffer_load_dword v244, v241, s[68:71], 0 offen sc1
  s_waitcnt vmcnt(0)
  v_max3_u32 v243, v64, v65, v66
  v_max_u32 v243, v67, v243
  v_and_b32 v244, 0x10101010, v244
  v_cmp_eq_u32 vcc, -1, v243
  s_mov_b64 s[98:99], vcc
  v_cmp_ne_u32 vcc, 0x10101010, v244
  s_or_b64 vcc, vcc, s[98:99]
  s_cmp_eq_u64 vcc, 0
  s_cbranch_scc1 L_s3bii_twd_24
  s_sleep 8
  s_sub_u32 s74, s74, 1
  s_cmp_lg_u32 s74, 0
  s_cbranch_scc1 L_s3bii_tw_23
L_s3bii_twd_24:
  v_add_f32 v64, v64, v65
  v_add_f32 v66, v66, v67
  v_add_f32 v26, v64, v66
  v_cvt_pk_bf16_f32 v26, v26, v26
  v_lshlrev_b32 v26, 16, v26
  s_nop 0
  v_readlane_b32 s80, v26, 0
  v_readlane_b32 s81, v26, 1
  v_readlane_b32 s82, v26, 2
  v_readlane_b32 s83, v26, 3
  v_readlane_b32 s84, v26, 4
  v_readlane_b32 s85, v26, 5
  v_readlane_b32 s86, v26, 6
  v_readlane_b32 s87, v26, 7
  s_nop 1
  v_mov_b32 v32, 0
  v_mov_b32 v33, 0
  v_mov_b32 v34, 0
  v_mov_b32 v35, 0
  v_mov_b32 v36, 0
  v_mov_b32 v37, 0
  v_mov_b32 v38, 0
  v_mov_b32 v39, 0
  v_mov_b32 v40, 0
  v_mov_b32 v41, 0
  v_mov_b32 v42, 0
  v_mov_b32 v43, 0
  v_mov_b32 v44, 0
  v_mov_b32 v45, 0
  v_mov_b32 v46, 0
  v_mov_b32 v47, 0
  v_lshlrev_b32 v30, 16, v144
  v_and_b32 v31, 0xffff0000, v144
  v_fmac_f32 v32, s80, v30
  v_fmac_f32 v33, s80, v31
  v_fmac_f32 v40, s84, v30
  v_fmac_f32 v41, s84, v31
  v_lshlrev_b32 v30, 16, v145
  v_and_b32 v31, 0xffff0000, v145
  v_fmac_f32 v34, s80, v30
  v_fmac_f32 v35, s80, v31
  v_fmac_f32 v42, s84, v30
  v_fmac_f32 v43, s84, v31
  v_lshlrev_b32 v30, 16, v146
  v_and_b32 v31, 0xffff0000, v146
  v_fmac_f32 v36, s80, v30
  v_fmac_f32 v37, s80, v31
  v_fmac_f32 v44, s84, v30
  v_fmac_f32 v45, s84, v31
  v_lshlrev_b32 v30, 16, v147
  v_and_b32 v31, 0xffff0000, v147
  v_fmac_f32 v38, s80, v30
  v_fmac_f32 v39, s80, v31
  v_fmac_f32 v46, s84, v30
  v_fmac_f32 v47, s84, v31
  v_lshlrev_b32 v30, 16, v148
  v_and_b32 v31, 0xffff0000, v148
  v_fmac_f32 v32, s81, v30
  v_fmac_f32 v33, s81, v31
  v_fmac_f32 v40, s85, v30
  v_fmac_f32 v41, s85, v31
  v_lshlrev_b32 v30, 16, v149
  v_and_b32 v31, 0xffff0000, v149
  v_fmac_f32 v34, s81, v30
  v_fmac_f32 v35, s81, v31
  v_fmac_f32 v42, s85, v30
  v_fmac_f32 v43, s85, v31
  v_lshlrev_b32 v30, 16, v150
  v_and_b32 v31, 0xffff0000, v150
  v_fmac_f32 v36, s81, v30
  v_fmac_f32 v37, s81, v31
  v_fmac_f32 v44, s85, v30
  v_fmac_f32 v45, s85, v31
  v_lshlrev_b32 v30, 16, v151
  v_and_b32 v31, 0xffff0000, v151
  v_fmac_f32 v38, s81, v30
  v_fmac_f32 v39, s81, v31
  v_fmac_f32 v46, s85, v30
  v_fmac_f32 v47, s85, v31
  v_lshlrev_b32 v30, 16, v152
  v_and_b32 v31, 0xffff0000, v152
  v_fmac_f32 v32, s82, v30
  v_fmac_f32 v33, s82, v31
  v_fmac_f32 v40, s86, v30
  v_fmac_f32 v41, s86, v31
  v_lshlrev_b32 v30, 16, v153
  v_and_b32 v31, 0xffff0000, v153
  v_fmac_f32 v34, s82, v30
  v_fmac_f32 v35, s82, v31
  v_fmac_f32 v42, s86, v30
  v_fmac_f32 v43, s86, v31
  v_lshlrev_b32 v30, 16, v154
  v_and_b32 v31, 0xffff0000, v154
  v_fmac_f32 v36, s82, v30
  v_fmac_f32 v37, s82, v31
  v_fmac_f32 v44, s86, v30
  v_fmac_f32 v45, s86, v31
  v_lshlrev_b32 v30, 16, v155
  v_and_b32 v31, 0xffff0000, v155
  v_fmac_f32 v38, s82, v30
  v_fmac_f32 v39, s82, v31
  v_fmac_f32 v46, s86, v30
  v_fmac_f32 v47, s86, v31
  v_lshlrev_b32 v30, 16, v156
  v_and_b32 v31, 0xffff0000, v156
  v_fmac_f32 v32, s83, v30
  v_fmac_f32 v33, s83, v31
  v_fmac_f32 v40, s87, v30
  v_fmac_f32 v41, s87, v31
  v_lshlrev_b32 v30, 16, v157
  v_and_b32 v31, 0xffff0000, v157
  v_fmac_f32 v34, s83, v30
  v_fmac_f32 v35, s83, v31
  v_fmac_f32 v42, s87, v30
  v_fmac_f32 v43, s87, v31
  v_lshlrev_b32 v30, 16, v158
  v_and_b32 v31, 0xffff0000, v158
  v_fmac_f32 v36, s83, v30
  v_fmac_f32 v37, s83, v31
  v_fmac_f32 v44, s87, v30
  v_fmac_f32 v45, s87, v31
  v_lshlrev_b32 v30, 16, v159
  v_and_b32 v31, 0xffff0000, v159
  v_fmac_f32 v38, s83, v30
  v_fmac_f32 v39, s83, v31
  v_fmac_f32 v46, s87, v30
  v_fmac_f32 v47, s87, v31
  s_lshl_b32 s28, s64, 12
  v_lshlrev_b32 v6, 5, v1
  v_add_u32 v6, s28, v6
  ds_write_b128 v6, v[32:35] offset:0
  ds_write_b128 v6, v[36:39] offset:16
  ds_write_b128 v6, v[40:43] offset:2048
  ds_write_b128 v6, v[44:47] offset:2064
  s_waitcnt lgkmcnt(0)
  s_barrier
  v_lshlrev_b32 v6, 3, v0
  ds_read_b64 v[48:49], v6 offset:0
  ds_read_b64 v[50:51], v6 offset:4096
  ds_read_b64 v[52:53], v6 offset:8192
  ds_read_b64 v[54:55], v6 offset:12288
  ds_read_b64 v[56:57], v6 offset:16384
  ds_read_b64 v[58:59], v6 offset:20480
  ds_read_b64 v[60:61], v6 offset:24576
  ds_read_b64 v[62:63], v6 offset:28672
  v_lshrrev_b32 v7, 8, v0
  v_lshlrev_b32 v7, 18, v7
  v_bfe_u32 v8, v0, 4, 4
  v_lshl_add_u32 v7, v8, 14, v7
  v_and_b32 v8, 15, v0
  v_lshl_add_u32 v7, v8, 3, v7
  s_lshl_b32 s34, s65, 7
  s_add_u32 s34, s34, 1572864
  s_waitcnt lgkmcnt(0)
  v_add_f32 v48, v48, v50
  v_add_f32 v52, v52, v54
  v_add_f32 v56, v56, v58
  v_add_f32 v60, v60, v62
  v_add_f32 v48, v48, v52
  v_add_f32 v56, v56, v60
  v_add_f32 v48, v48, v56
  v_add_f32 v49, v49, v51
  v_add_f32 v53, v53, v55
  v_add_f32 v57, v57, v59
  v_add_f32 v61, v61, v63
  v_add_f32 v49, v49, v53
  v_add_f32 v57, v57, v61
  v_add_f32 v49, v49, v57
  buffer_store_dwordx2 v[48:49], v7, s[4:7], s34 offen sc1
  s_branch L_END
L_END:
L_EXIT:
  s_endpgm
.section .rodata,"a"
.p2align 6
.amdhsa_kernel concat_heads__sliding_block_cached__compressed_kv_cla__decode_kernel
  .amdhsa_next_free_vgpr 256
  .amdhsa_next_free_sgpr 102
  .amdhsa_accum_offset 256
  .amdhsa_group_segment_fixed_size 0
  .amdhsa_kernarg_size 112
  .amdhsa_user_sgpr_count 2
  .amdhsa_user_sgpr_kernarg_segment_ptr 1
  .amdhsa_system_sgpr_workgroup_id_x 1
.end_amdhsa_kernel
```
